```python
import torch

def _softmax(x, axis=-1):
    return torch.softmax(x, dim=axis)

def _gelu(x):
    return torch.nn.functional.gelu(x, approximate='tanh')

def _silu(x):
    return torch.nn.functional.silu(x)

def _sigmoid(x):
    return torch.sigmoid(x)

def _layernorm(x, axis=-1, eps=1e-05):
    m = x.mean(dim=axis, keepdim=True)
    v = x.var(dim=axis, keepdim=True, unbiased=False)
    return (x - m) / torch.sqrt(v + eps)

def _scatter_add(tgt, idx, src, axis=0):
    return tgt.clone().index_add_(axis, idx, src)

def _segment_sum(src, seg, n):
    out = torch.zeros((n,) + src.shape[1:], dtype=src.dtype)
    return out.index_add_(0, seg, src)

def _pad(x, pw):
    flat = tuple((v for pair in reversed(pw) for v in pair))
    return torch.nn.functional.pad(x, flat)
kernel_name = 'parallel_sum__sliding_local_dilated__mixer_gmlp__prompt'

def setup_inputs():

    _w = lambda a: (lambda t: t.to(torch.bfloat16) if t.is_floating_point() else t)(torch.as_tensor(a))

    def _A_setup():
        B, S, D = (1, 2048, 448)
        return {'x': _w((lambda *s: torch.randn(*s, dtype=torch.bfloat16) * 0.05)(B, S, D)), 'wqkv': _w((lambda *s: torch.randn(*s, dtype=torch.bfloat16) * 0.1)(D, 3 * D)), 'wo': _w((lambda *s: torch.randn(*s, dtype=torch.bfloat16) * 0.05)(D, D))}
    _A_in = _A_setup()

    def _B_setup():
        B, S, D, F = (1, 2048, 448, 1792)
        Fh = F // 2
        return {'x': _w((lambda *s: torch.randn(*s, dtype=torch.bfloat16) * 0.05)(B, S, D)), 'w_in': _w((lambda *s: torch.randn(*s, dtype=torch.bfloat16) * 0.4)(D, 2 * Fh)), 'w_sp': _w(0.01 * (lambda *s: torch.randn(*s, dtype=torch.bfloat16) * 0.4)(S, S)), 'b_sp': _w(1.0 + 0.01 * (lambda *s: torch.randn(*s, dtype=torch.bfloat16) * 0.05)(S)), 'w_out': _w((lambda *s: torch.randn(*s, dtype=torch.bfloat16) * 0.05)(Fh, D))}
    _B_in = _B_setup()
    return {'A_x': _A_in['x'], 'A_wqkv': _A_in['wqkv'], 'A_wo': _A_in['wo'], 'B_x': _B_in['x'], 'B_w_in': _B_in['w_in'], 'B_w_sp': _B_in['w_sp'], 'B_b_sp': _B_in['b_sp'], 'B_w_out': _B_in['w_out']}

def reference(A_x, A_wqkv, A_wo, B_x, B_w_in, B_w_sp, B_b_sp, B_w_out):

    def _A_ref(x, wqkv, wo):
        B, S, D = x.shape
        H = 16
        Dh = D // H
        W, dil = (8, 2)
        qkv = (lambda x, *d: x.permute(*d))((x @ wqkv).reshape(B, S, 3, H, Dh), 2, 0, 3, 1, 4)
        q, k, v = (qkv[0], qkv[1], qkv[2])
        scale = Dh ** (-0.5)
        pos = torch.arange(S)
        off = torch.arange(W) * dil
        idx = pos[:, None] - off[None, :]
        mask = idx >= 0
        idx_c = torch.where(mask, idx, 0).reshape(-1)
        kg = k[:, :, idx_c, :].reshape(B, H, S, W, Dh)
        vg = v[:, :, idx_c, :].reshape(B, H, S, W, Dh)
        logits = torch.einsum('bhsd,bhswd->bhsw', q, kg) * scale
        logits = torch.where(mask[None, None, :, :], logits, -1000000000.0)
        attn = _softmax(logits, axis=-1)
        o = torch.einsum('bhsw,bhswd->bhsd', attn, vg)
        return (lambda x, *d: x.permute(*d))(o, 0, 2, 1, 3).reshape(B, S, D) @ wo

    def _B_ref(x, w_in, w_sp, b_sp, w_out):
        B, S, D = x.shape
        F = w_in.shape[-1]
        Fh = F // 2
        z = _gelu(torch.einsum('bsd,df->bsf', x, w_in))
        z1 = z[..., :Fh].clone()
        z2 = _layernorm(z[..., Fh:], axis=-1)
        g = torch.einsum('ts,bsf->btf', w_sp, z2) + b_sp[None, :, None]
        return torch.einsum('bsf,fd->bsd', z1 * g, w_out)
    x = A_x
    xn = _layernorm(x, axis=-1)
    return x + _A_ref(xn, A_wqkv, A_wo) + _B_ref(xn, B_w_in, B_w_sp, B_b_sp, B_w_out)
```

```asm
; @launch kernel=f_kernel grid=(256,1,1) block=(512,1,1) lds=162880
.amdgcn_target "amdgcn-amd-amdhsa--gfx950"
.text
.globl f_kernel
.p2align 8
.type f_kernel,@function
f_kernel:
    s_cmp_ge_u32 s2, 256
    s_cbranch_scc1 L_end
    s_load_dwordx2 s[4:5], s[0:1], 0
    s_load_dwordx2 s[8:9], s[0:1], 32
    s_load_dwordx2 s[12:13], s[0:1], 8
    s_load_dwordx2 s[16:17], s[0:1], 80
    s_load_dwordx2 s[20:21], s[0:1], 40
    s_load_dwordx2 s[36:37], s[0:1], 48
    s_load_dwordx2 s[24:25], s[0:1], 56
    s_load_dwordx2 s[28:29], s[0:1], 16
    s_load_dwordx2 s[32:33], s[0:1], 64
    s_load_dwordx2 s[40:41], s[0:1], 72
    v_lshrrev_b32 v2, 6, v0
    v_and_b32 v1, 63, v0
    v_readfirstlane_b32 s42, v2
    s_cmp_ge_u32 s2, 8
    s_cbranch_scc1 cpf_f_1_done
    s_getpc_b64 s[48:49]
cpf_f_1_p:
    s_sub_u32 s48, s48, cpf_f_1_p-f_kernel
    s_subb_u32 s49, s49, 0
    s_mov_b32 s50, L_k2-f_kernel-16
    v_lshlrev_b32 v70, 4, v0
cpf_f_1_loop:
    v_cmp_ge_u32 vcc, s50, v70
    s_and_b64 exec, exec, vcc
    s_cbranch_execz cpf_f_1_fin
    global_load_dwordx4 v[64:67], v70, s[48:49]
    v_add_u32 v70, 8192, v70
    s_branch cpf_f_1_loop
cpf_f_1_fin:
    s_mov_b64 exec, -1
cpf_f_1_done:
    s_cmp_ge_u32 s2, 224
    s_cbranch_scc1 L_aux
    s_and_b32 s48, s2, 7
    s_lshr_b32 s49, s2, 3
    s_lshr_b32 s50, s48, 1
    s_lshl_b32 s50, s50, 2
    s_and_b32 s51, s49, 3
    s_add_u32 s45, s50, s51
    s_and_b32 s50, s48, 1
    s_mul_i32 s50, s50, 7
    s_lshr_b32 s51, s49, 2
    s_add_u32 s46, s50, s51
    s_lshl_b32 s47, s45, 7
    s_and_b32 s43, s42, 3
    s_lshr_b32 s44, s42, 2
    v_lshrrev_b32 v112, 3, v1
    v_lshrrev_b32 v113, 4, v1
    v_and_b32 v114, 7, v1
    v_mul_u32_u24 v2, 896, v112
    v_xor_b32 v115, v114, v113
    v_lshlrev_b32 v115, 4, v115
    v_add_u32 v3, 6144, v2
    v_add_u32 v2, v2, v115
    v_xor_b32 v115, 64, v115
    v_add_u32 v3, v3, v115
    v_and_b32 v115, 1, v113
    v_lshlrev_b32 v115, 2, v115
    v_xor_b32 v115, v114, v115
    v_lshlrev_b32 v115, 4, v115
    v_mul_u32_u24 v4, 3584, v112
    v_add_u32 v4, v4, v115
    s_lshl_b32 s55, s42, 4
    s_add_u32 s55, s55, s47
    s_mul_i32 s48, s55, 896
    s_mul_i32 s55, s42, 28672
    s_lshl_b32 s56, s46, 7
    s_add_u32 s50, s55, s56
    s_add_u32 s49, s50, 1792
    s_lshl_b32 s52, s42, 11
    s_add_u32 s52, s52, 0
    s_lshl_b32 s53, s42, 10
    s_add_u32 s53, s53, 65536
    s_waitcnt lgkmcnt(0)
    s_mov_b32 s6, 1835008
    s_mov_b32 s7, 0x20000
    s_mov_b32 s10, 1605632
    s_mov_b32 s11, 0x20000
    s_add_u32 m0, s52, 0
    s_add_u32 s55, s48, 0
    buffer_load_dwordx4 v2, s[4:7], s55 offen offset:0 lds
    buffer_load_dwordx4 v3, s[4:7], s55 offen offset:1024 lds
    s_add_u32 m0, s53, 0
    s_add_u32 s56, s49, 0
    buffer_load_dwordx4 v4, s[8:11], s56 offen lds
    s_add_u32 m0, s52, 16384
    s_add_u32 s55, s48, 128
    buffer_load_dwordx4 v2, s[4:7], s55 offen offset:0 lds
    buffer_load_dwordx4 v3, s[4:7], s55 offen offset:1024 lds
    s_add_u32 m0, s53, 8192
    s_add_u32 s56, s49, 229376
    buffer_load_dwordx4 v4, s[8:11], s56 offen lds
    s_mov_b32 s14, 1204224
    s_mov_b32 s15, 0x20000
    s_mov_b32 s18, 268435456
    s_mov_b32 s19, 0x20000
    s_lshl_b32 s55, s2, 3
    s_add_u32 s55, s55, s42
    s_cmp_lg_u32 s55, 1
    s_cbranch_scc1 non_f_2
    s_memrealtime s[60:61]
    v_mov_b32 v113, 0
    s_waitcnt lgkmcnt(0)
    s_or_b32 s60, s60, 1
    v_mov_b32 v112, s60
    s_mov_b64 exec, 1
    global_store_dword v113, v112, s[40:41] sc1
    s_mov_b64 exec, -1
non_f_2:
    v_and_b32 v112, 31, v1
    v_lshrrev_b32 v113, 5, v1
    v_and_b32 v114, 15, v1
    v_and_b32 v115, 3, v114
    v_lshlrev_b32 v115, 3, v115
    v_lshrrev_b32 v114, 2, v114
    v_lshrrev_b32 v116, 4, v1
    v_and_b32 v116, 1, v116
    v_and_b32 v117, 15, v1
    v_cmp_eq_u32 vcc, v117, v116
    v_mov_b32 v26, 0x3f803f80
    v_lshlrev_b32 v116, 5, v116
    v_add_u32 v116, v116, v115
    v_cndmask_b32 v16, 0, v26, vcc
    v_cndmask_b32 v17, 0, v26, vcc
    v_cndmask_b32 v18, 0, v26, vcc
    v_cndmask_b32 v19, 0, v26, vcc
    s_lshl_b32 s55, s44, 1
    s_add_u32 s55, s55, s43
    v_lshlrev_b32 v117, 3, v113
    v_add_u32 v117, v117, v114
    v_lshlrev_b32 v127, 6, v117
    v_add_u32 v127, v127, v116
    v_lshlrev_b32 v117, 7, v117
    v_add_u32 v117, v117, v116
    v_lshrrev_b32 v114, 1, v114
    v_xor_b32 v114, s44, v114
    v_lshlrev_b32 v114, 6, v114
    v_add_u32 v117, v117, v114
    v_lshrrev_b32 v115, 1, v112
    v_and_b32 v115, 7, v115
    v_lshlrev_b32 v116, 7, v112
    s_lshl_b32 s56, s43, 12
    s_add_u32 s56, s56, 0
    v_add_u32 v116, s56, v116
    s_add_u32 s56, s55, 0
    s_and_b32 s56, s56, 3
    s_lshl_b32 s57, s56, 1
    v_add_u32 v114, s57, v113
    v_xor_b32 v114, v114, v115
    v_lshlrev_b32 v114, 4, v114
    v_add_u32 v8, v116, v114
    s_lshl_b32 s57, s56, 11
    s_add_u32 s57, s57, 65536
    v_add_u32 v12, s57, v117
    s_add_u32 s56, s55, 1
    s_and_b32 s56, s56, 3
    s_lshl_b32 s57, s56, 1
    v_add_u32 v114, s57, v113
    v_xor_b32 v114, v114, v115
    v_lshlrev_b32 v114, 4, v114
    v_add_u32 v9, v116, v114
    s_lshl_b32 s57, s56, 11
    s_add_u32 s57, s57, 65536
    v_add_u32 v13, s57, v117
    s_add_u32 s56, s55, 2
    s_and_b32 s56, s56, 3
    s_lshl_b32 s57, s56, 1
    v_add_u32 v114, s57, v113
    v_xor_b32 v114, v114, v115
    v_lshlrev_b32 v114, 4, v114
    v_add_u32 v10, v116, v114
    s_lshl_b32 s57, s56, 11
    s_add_u32 s57, s57, 65536
    v_add_u32 v14, s57, v117
    s_add_u32 s56, s55, 3
    s_and_b32 s56, s56, 3
    s_lshl_b32 s57, s56, 1
    v_add_u32 v114, s57, v113
    v_xor_b32 v114, v114, v115
    v_lshlrev_b32 v114, 4, v114
    v_add_u32 v11, v116, v114
    s_lshl_b32 s57, s56, 11
    s_add_u32 s57, s57, 65536
    v_add_u32 v15, s57, v117
    s_add_u32 m0, s52, 32768
    s_add_u32 s55, s48, 256
    buffer_load_dwordx4 v2, s[4:7], s55 offen offset:0 lds
    buffer_load_dwordx4 v3, s[4:7], s55 offen offset:1024 lds
    s_add_u32 m0, s53, 16384
    s_add_u32 s56, s49, 458752
    buffer_load_dwordx4 v4, s[8:11], s56 offen lds
    s_add_u32 m0, s52, 49152
    s_add_u32 s55, s48, 384
    buffer_load_dwordx4 v2, s[4:7], s55 offen offset:0 lds
    buffer_load_dwordx4 v3, s[4:7], s55 offen offset:1024 lds
    s_add_u32 m0, s52, 131072
    s_add_u32 s55, s48, 512
    buffer_load_dwordx4 v2, s[4:7], s55 offen offset:0 lds
    buffer_load_dwordx4 v3, s[4:7], s55 offen offset:1024 lds
    s_waitcnt vmcnt(10)
    s_barrier
    ds_read_b128 v[144:147], v8 offset:0
    ds_read_b64_tr_b16 v[32:33], v12 offset:0
    ds_read_b64_tr_b16 v[34:35], v12 offset:512
    ds_read_b128 v[148:151], v9 offset:0
    ds_read_b64_tr_b16 v[36:37], v13 offset:0
    ds_read_b64_tr_b16 v[38:39], v13 offset:512
    ds_read_b128 v[152:155], v10 offset:0
    ds_read_b64_tr_b16 v[40:41], v14 offset:0
    ds_read_b64_tr_b16 v[42:43], v14 offset:512
    ds_read_b128 v[156:159], v11 offset:0
    ds_read_b64_tr_b16 v[44:45], v15 offset:0
    ds_read_b64_tr_b16 v[46:47], v15 offset:512
    s_waitcnt vmcnt(7)
    s_barrier
    s_waitcnt lgkmcnt(9)
    v_mfma_f32_32x32x16_bf16 v[64:79], v[32:35], v[144:147], 0
    v_mfma_f32_16x16x32_bf16 v[20:23], v[16:19], v[32:35], 0
    v_mfma_f32_32x32x16_bf16 v[48:63], v[144:147], v[144:147], 0
    v_mfma_f32_16x16x32_bf16 v[112:115], v[16:19], v[144:147], 0
    ds_read_b128 v[160:163], v8 offset:16384
    ds_read_b64_tr_b16 v[32:33], v12 offset:8192
    ds_read_b64_tr_b16 v[34:35], v12 offset:8704
    v_add_u32 v96, 131072, v8
    v_add_u32 v97, 131072, v9
    v_add_u32 v98, 131072, v10
    v_add_u32 v99, 131072, v11
    s_waitcnt lgkmcnt(9)
    v_mfma_f32_32x32x16_bf16 v[64:79], v[36:39], v[148:151], v[64:79]
    v_mfma_f32_32x32x16_bf16 v[48:63], v[148:151], v[148:151], v[48:63]
    v_mfma_f32_16x16x32_bf16 v[112:115], v[16:19], v[148:151], v[112:115]
    ds_read_b128 v[164:167], v9 offset:16384
    ds_read_b64_tr_b16 v[36:37], v13 offset:8192
    ds_read_b64_tr_b16 v[38:39], v13 offset:8704
    s_add_u32 m0, s53, 24576
    s_add_u32 s56, s49, 688128
    buffer_load_dwordx4 v4, s[8:11], s56 offen lds
    v_and_b32 v120, 31, v1
    v_lshrrev_b32 v121, 5, v1
    s_lshl_b32 s57, s43, 5
    v_add_u32 v122, s57, v120
    s_waitcnt lgkmcnt(9)
    v_mfma_f32_32x32x16_bf16 v[64:79], v[40:43], v[152:155], v[64:79]
    ds_read_b128 v[168:171], v10 offset:16384
    ds_read_b64_tr_b16 v[40:41], v14 offset:8192
    ds_read_b64_tr_b16 v[42:43], v14 offset:8704
    v_lshlrev_b32 v140, 3, v122
    v_lshl_add_u32 v143, v121, 2, v140
    v_mul_u32_u24 v142, 144, v122
    v_add_u32 v140, 149504, v140
    s_lshl_b32 s57, s44, 10
    s_waitcnt lgkmcnt(9)
    v_mfma_f32_32x32x16_bf16 v[64:79], v[44:47], v[156:159], v[64:79]
    ds_read_b128 v[172:175], v11 offset:16384
    ds_read_b64_tr_b16 v[44:45], v15 offset:8192
    ds_read_b64_tr_b16 v[46:47], v15 offset:8704
    v_add_u32 v141, s57, v140
    v_lshlrev_b32 v121, 3, v121
    s_lshl_b32 s57, s44, 6
    s_add_u32 s57, s57, 131072
    s_waitcnt vmcnt(5)
    s_barrier
    s_waitcnt lgkmcnt(9)
    v_mfma_f32_32x32x16_bf16 v[64:79], v[32:35], v[160:163], v[64:79]
    v_mfma_f32_16x16x32_bf16 v[20:23], v[16:19], v[32:35], v[20:23]
    v_mfma_f32_32x32x16_bf16 v[48:63], v[160:163], v[160:163], v[48:63]
    v_mfma_f32_16x16x32_bf16 v[112:115], v[16:19], v[160:163], v[112:115]
    ds_read_b128 v[176:179], v8 offset:32768
    ds_read_b64_tr_b16 v[32:33], v12 offset:16384
    ds_read_b64_tr_b16 v[34:35], v12 offset:16896
    v_add3_u32 v128, v142, v121, s57
    v_lshlrev_b32 v120, 2, v120
    s_lshl_b32 s57, s44, 7
    s_add_u32 s57, s57, 159744
    v_add_u32 v31, s57, v120
    s_waitcnt lgkmcnt(9)
    v_mfma_f32_32x32x16_bf16 v[64:79], v[36:39], v[164:167], v[64:79]
    v_mfma_f32_32x32x16_bf16 v[48:63], v[164:167], v[164:167], v[48:63]
    v_mfma_f32_16x16x32_bf16 v[112:115], v[16:19], v[164:167], v[112:115]
    ds_read_b128 v[180:183], v9 offset:32768
    ds_read_b64_tr_b16 v[36:37], v13 offset:16384
    ds_read_b64_tr_b16 v[38:39], v13 offset:16896
    s_add_u32 m0, s53, 32768
    s_add_u32 s56, s49, 917504
    buffer_load_dwordx4 v4, s[8:11], s56 offen lds
    s_lshl_b32 s58, s43, 8
    s_add_u32 s57, s57, s58
    v_lshlrev_b32 v120, 2, v1
    v_add_u32 v7, s57, v120
    s_waitcnt lgkmcnt(9)
    v_mfma_f32_32x32x16_bf16 v[64:79], v[40:43], v[168:171], v[64:79]
    ds_read_b128 v[184:187], v10 offset:32768
    ds_read_b64_tr_b16 v[40:41], v14 offset:16384
    ds_read_b64_tr_b16 v[42:43], v14 offset:16896
    s_add_u32 m0, s52, 0
    s_add_u32 s55, s48, 640
    buffer_load_dwordx4 v2, s[4:7], s55 offen offset:0 lds
    v_lshrrev_b32 v120, 3, v1
    v_and_b32 v121, 7, v1
    v_lshlrev_b32 v121, 4, v121
    v_mul_u32_u24 v130, 128, v120
    s_waitcnt lgkmcnt(9)
    v_mfma_f32_32x32x16_bf16 v[64:79], v[44:47], v[172:175], v[64:79]
    ds_read_b128 v[188:191], v11 offset:32768
    ds_read_b64_tr_b16 v[44:45], v15 offset:16384
    ds_read_b64_tr_b16 v[46:47], v15 offset:16896
    buffer_load_dwordx4 v3, s[4:7], s55 offen offset:1024 lds
    v_add_u32 v130, v130, v121
    v_mul_u32_u24 v131, 2688, v120
    v_add_u32 v131, v131, v121
    s_lshl_b32 s57, s42, 4
    v_add_u32 v120, s57, v120
    s_waitcnt vmcnt(3)
    s_barrier
    s_waitcnt lgkmcnt(9)
    v_mfma_f32_32x32x16_bf16 v[64:79], v[32:35], v[176:179], v[64:79]
    v_mfma_f32_16x16x32_bf16 v[20:23], v[16:19], v[32:35], v[20:23]
    v_mfma_f32_32x32x16_bf16 v[48:63], v[176:179], v[176:179], v[48:63]
    v_mfma_f32_16x16x32_bf16 v[112:115], v[16:19], v[176:179], v[112:115]
    ds_read_b128 v[192:195], v8 offset:49152
    ds_read_b64_tr_b16 v[32:33], v12 offset:24576
    ds_read_b64_tr_b16 v[34:35], v12 offset:25088
    v_mul_u32_u24 v129, 144, v120
    v_add_u32 v129, v129, v121
    v_add_u32 v129, 131072, v129
    v_mov_b32 v134, 0
    v_mov_b32 v125, 0
    s_cmp_lg_u32 s42, 0
    s_cbranch_scc1 nl_f_3
    global_load_dword v124, v125, s[40:41] sc1
nl_f_3:
    s_waitcnt lgkmcnt(9)
    v_mfma_f32_32x32x16_bf16 v[64:79], v[36:39], v[180:183], v[64:79]
    v_mfma_f32_32x32x16_bf16 v[48:63], v[180:183], v[180:183], v[48:63]
    v_mfma_f32_16x16x32_bf16 v[112:115], v[16:19], v[180:183], v[112:115]
    ds_read_b128 v[196:199], v9 offset:49152
    ds_read_b64_tr_b16 v[36:37], v13 offset:24576
    ds_read_b64_tr_b16 v[38:39], v13 offset:25088
    s_add_u32 m0, s53, 40960
    s_add_u32 s56, s49, 1146880
    buffer_load_dwordx4 v4, s[8:11], s56 offen lds
    v_mov_b32 v135, 0
    v_mov_b32 v138, 0
    v_mov_b32 v139, 0
    v_mov_b32 v24, 0
    v_mov_b32 v25, 0
    s_waitcnt lgkmcnt(9)
    v_mfma_f32_32x32x16_bf16 v[64:79], v[40:43], v[184:187], v[64:79]
    ds_read_b128 v[200:203], v10 offset:49152
    ds_read_b64_tr_b16 v[40:41], v14 offset:24576
    ds_read_b64_tr_b16 v[42:43], v14 offset:25088
    s_add_u32 m0, s52, 16384
    s_add_u32 s55, s48, 768
    buffer_load_dwordx4 v2, s[4:7], s55 offen offset:0 lds
    v_lshrrev_b32 v120, 3, v1
    v_lshrrev_b32 v121, 4, v1
    v_and_b32 v121, 1, v121
    s_waitcnt lgkmcnt(9)
    v_mfma_f32_32x32x16_bf16 v[64:79], v[44:47], v[188:191], v[64:79]
    ds_read_b128 v[204:207], v11 offset:49152
    ds_read_b64_tr_b16 v[44:45], v15 offset:24576
    ds_read_b64_tr_b16 v[46:47], v15 offset:25088
    buffer_load_dwordx4 v3, s[4:7], s55 offen offset:1024 lds
    v_lshlrev_b32 v121, 2, v121
    v_and_b32 v122, 7, v1
    v_xor_b32 v121, v122, v121
    s_waitcnt vmcnt(5)
    s_barrier
    s_waitcnt lgkmcnt(9)
    v_mfma_f32_32x32x16_bf16 v[64:79], v[32:35], v[192:195], v[64:79]
    v_mfma_f32_16x16x32_bf16 v[20:23], v[16:19], v[32:35], v[20:23]
    v_mfma_f32_32x32x16_bf16 v[48:63], v[192:195], v[192:195], v[48:63]
    v_mfma_f32_16x16x32_bf16 v[112:115], v[16:19], v[192:195], v[112:115]
    ds_read_b128 v[208:211], v96
    ds_read_b64_tr_b16 v[32:33], v12 offset:32768
    ds_read_b64_tr_b16 v[34:35], v12 offset:33280
    v_lshlrev_b32 v121, 4, v121
    v_mul_u32_u24 v5, 2688, v120
    v_add_u32 v5, v5, v121
    s_waitcnt lgkmcnt(9)
    v_mfma_f32_32x32x16_bf16 v[64:79], v[36:39], v[196:199], v[64:79]
    v_mfma_f32_32x32x16_bf16 v[48:63], v[196:199], v[196:199], v[48:63]
    v_mfma_f32_16x16x32_bf16 v[112:115], v[16:19], v[196:199], v[112:115]
    ds_read_b128 v[212:215], v97
    ds_read_b64_tr_b16 v[36:37], v13 offset:32768
    ds_read_b64_tr_b16 v[38:39], v13 offset:33280
    s_add_u32 m0, s53, 49152
    s_add_u32 s56, s49, 1376256
    buffer_load_dwordx4 v4, s[8:11], s56 offen lds
    v_lshrrev_b32 v6, 2, v1
    v_mul_u32_u24 v6, 2688, v6
    v_and_b32 v120, 3, v1
    s_waitcnt lgkmcnt(9)
    v_mfma_f32_32x32x16_bf16 v[64:79], v[40:43], v[200:203], v[64:79]
    ds_read_b128 v[216:219], v98
    ds_read_b64_tr_b16 v[40:41], v14 offset:32768
    ds_read_b64_tr_b16 v[42:43], v14 offset:33280
    v_lshlrev_b32 v120, 4, v120
    v_add_u32 v6, v6, v120
    s_mul_i32 s57, s42, 21504
    s_waitcnt lgkmcnt(9)
    v_mfma_f32_32x32x16_bf16 v[64:79], v[44:47], v[204:207], v[64:79]
    ds_read_b128 v[220:223], v99
    ds_read_b64_tr_b16 v[44:45], v15 offset:32768
    ds_read_b64_tr_b16 v[46:47], v15 offset:33280
    s_mul_i32 s58, s46, 192
    s_add_u32 s51, s57, s58
    s_lshl_b32 s54, s42, 9
    s_add_u32 s54, s54, 65536
    s_waitcnt vmcnt(3)
    s_barrier
    s_waitcnt lgkmcnt(9)
    v_mfma_f32_32x32x16_bf16 v[64:79], v[32:35], v[208:211], v[64:79]
    v_mfma_f32_16x16x32_bf16 v[20:23], v[16:19], v[32:35], v[20:23]
    v_mfma_f32_32x32x16_bf16 v[48:63], v[208:211], v[208:211], v[48:63]
    v_mfma_f32_16x16x32_bf16 v[112:115], v[16:19], v[208:211], v[112:115]
    ds_read_b128 v[224:227], v8 offset:0
    ds_read_b64_tr_b16 v[32:33], v12 offset:40960
    ds_read_b64_tr_b16 v[34:35], v12 offset:41472
    s_waitcnt lgkmcnt(9)
    v_mfma_f32_32x32x16_bf16 v[64:79], v[36:39], v[212:215], v[64:79]
    v_mfma_f32_32x32x16_bf16 v[48:63], v[212:215], v[212:215], v[48:63]
    v_mfma_f32_16x16x32_bf16 v[112:115], v[16:19], v[212:215], v[112:115]
    ds_read_b128 v[228:231], v9 offset:0
    ds_read_b64_tr_b16 v[36:37], v13 offset:40960
    ds_read_b64_tr_b16 v[38:39], v13 offset:41472
    s_add_u32 m0, s54, 57344
    s_add_u32 s56, s51, 128
    s_mov_b32 exec_hi, 0
    buffer_load_dwordx4 v6, s[12:15], s56 offen lds
    s_mov_b32 exec_hi, -1
    s_waitcnt lgkmcnt(9)
    v_mfma_f32_32x32x16_bf16 v[64:79], v[40:43], v[216:219], v[64:79]
    ds_read_b128 v[232:235], v10 offset:0
    ds_read_b64_tr_b16 v[40:41], v14 offset:40960
    ds_read_b64_tr_b16 v[42:43], v14 offset:41472
    s_waitcnt lgkmcnt(9)
    v_mfma_f32_32x32x16_bf16 v[64:79], v[44:47], v[220:223], v[64:79]
    ds_read_b128 v[236:239], v11 offset:0
    ds_read_b64_tr_b16 v[44:45], v15 offset:40960
    ds_read_b64_tr_b16 v[46:47], v15 offset:41472
    s_add_u32 m0, s54, 0
    s_add_u32 s56, s51, 172160
    s_mov_b32 exec_hi, 0
    buffer_load_dwordx4 v6, s[12:15], s56 offen lds
    s_mov_b32 exec_hi, -1
    s_waitcnt vmcnt(2)
    s_barrier
    s_waitcnt lgkmcnt(9)
    v_mfma_f32_32x32x16_bf16 v[64:79], v[32:35], v[224:227], v[64:79]
    v_mfma_f32_16x16x32_bf16 v[20:23], v[16:19], v[32:35], v[20:23]
    v_mfma_f32_32x32x16_bf16 v[48:63], v[224:227], v[224:227], v[48:63]
    v_mfma_f32_16x16x32_bf16 v[112:115], v[16:19], v[224:227], v[112:115]
    ds_read_b128 v[240:243], v8 offset:16384
    ds_read_b64_tr_b16 v[32:33], v12 offset:49152
    ds_read_b64_tr_b16 v[34:35], v12 offset:49664
    s_lshl_b32 s57, s44, 1
    s_add_u32 s57, s57, s43
    s_add_u32 s57, s57, 0
    s_and_b32 s57, s57, 3
    s_lshl_b32 s57, s57, 10
    s_add_u32 s57, s57, 65536
    v_add_u32 v8, s57, v127
    s_waitcnt lgkmcnt(9)
    v_mfma_f32_32x32x16_bf16 v[64:79], v[36:39], v[228:231], v[64:79]
    v_mfma_f32_32x32x16_bf16 v[48:63], v[228:231], v[228:231], v[48:63]
    v_mfma_f32_16x16x32_bf16 v[112:115], v[16:19], v[228:231], v[112:115]
    ds_read_b128 v[244:247], v9 offset:16384
    ds_read_b64_tr_b16 v[36:37], v13 offset:49152
    ds_read_b64_tr_b16 v[38:39], v13 offset:49664
    s_add_u32 m0, s54, 8192
    s_add_u32 s56, s51, 344192
    s_mov_b32 exec_hi, 0
    buffer_load_dwordx4 v6, s[12:15], s56 offen lds
    s_mov_b32 exec_hi, -1
    s_lshl_b32 s57, s44, 1
    s_add_u32 s57, s57, s43
    s_add_u32 s57, s57, 1
    s_and_b32 s57, s57, 3
    s_lshl_b32 s57, s57, 10
    s_add_u32 s57, s57, 65536
    v_add_u32 v9, s57, v127
    s_waitcnt lgkmcnt(9)
    v_mfma_f32_32x32x16_bf16 v[64:79], v[40:43], v[232:235], v[64:79]
    ds_read_b128 v[248:251], v10 offset:16384
    ds_read_b64_tr_b16 v[40:41], v14 offset:49152
    ds_read_b64_tr_b16 v[42:43], v14 offset:49664
    s_lshl_b32 s57, s44, 1
    s_add_u32 s57, s57, s43
    s_add_u32 s57, s57, 2
    s_and_b32 s57, s57, 3
    s_lshl_b32 s57, s57, 10
    s_add_u32 s57, s57, 65536
    v_add_u32 v10, s57, v127
    s_waitcnt lgkmcnt(9)
    v_mfma_f32_32x32x16_bf16 v[64:79], v[44:47], v[236:239], v[64:79]
    ds_read_b128 v[252:255], v11 offset:16384
    ds_read_b64_tr_b16 v[44:45], v15 offset:49152
    ds_read_b64_tr_b16 v[46:47], v15 offset:49664
    s_add_u32 m0, s54, 16384
    s_add_u32 s56, s51, 516224
    s_mov_b32 exec_hi, 0
    buffer_load_dwordx4 v6, s[12:15], s56 offen lds
    s_mov_b32 exec_hi, -1
    s_lshl_b32 s57, s44, 1
    s_add_u32 s57, s57, s43
    s_add_u32 s57, s57, 3
    s_and_b32 s57, s57, 3
    s_lshl_b32 s57, s57, 10
    s_add_u32 s57, s57, 65536
    v_add_u32 v11, s57, v127
    s_cmp_lg_u32 s42, 0
    s_cbranch_scc1 np_f_4
    s_waitcnt vmcnt(8)
    s_mov_b32 s60, 0
np_f_4_chk:
    v_readfirstlane_b32 s59, v124
    s_cmp_lg_u32 s59, 0
    s_cbranch_scc1 np_f_4_ok
    s_add_u32 s60, s60, 1
    s_cmp_ge_u32 s60, 0x40000
    s_cbranch_scc1 np_f_4_ok
    global_load_dword v124, v125, s[40:41] sc1
    s_waitcnt vmcnt(0)
    s_branch np_f_4_chk
np_f_4_ok:
    v_mov_b32 v125, 162816
    ds_write_b32 v125, v124
    s_waitcnt lgkmcnt(0)
np_f_4:
    s_waitcnt vmcnt(3)
    s_barrier
    s_waitcnt lgkmcnt(9)
    v_mfma_f32_32x32x16_bf16 v[64:79], v[32:35], v[240:243], v[64:79]
    v_mfma_f32_16x16x32_bf16 v[20:23], v[16:19], v[32:35], v[20:23]
    v_mfma_f32_32x32x16_bf16 v[48:63], v[240:243], v[240:243], v[48:63]
    v_mfma_f32_16x16x32_bf16 v[112:115], v[16:19], v[240:243], v[112:115]
    ds_read_b64_tr_b16 v[32:33], v8 offset:57344
    ds_read_b64_tr_b16 v[34:35], v8 offset:57600
    v_mov_b32 v125, 162816
    ds_read_b32 v124, v125
    s_waitcnt lgkmcnt(9)
    v_mfma_f32_32x32x16_bf16 v[64:79], v[36:39], v[244:247], v[64:79]
    v_mfma_f32_32x32x16_bf16 v[48:63], v[244:247], v[244:247], v[48:63]
    v_mfma_f32_16x16x32_bf16 v[112:115], v[16:19], v[244:247], v[112:115]
    ds_read_b64_tr_b16 v[36:37], v9 offset:57344
    ds_read_b64_tr_b16 v[38:39], v9 offset:57600
    s_add_u32 m0, s54, 24576
    s_add_u32 s56, s51, 688256
    s_mov_b32 exec_hi, 0
    buffer_load_dwordx4 v6, s[12:15], s56 offen lds
    s_mov_b32 exec_hi, -1
    s_waitcnt lgkmcnt(8)
    v_mfma_f32_32x32x16_bf16 v[64:79], v[40:43], v[248:251], v[64:79]
    ds_read_b64_tr_b16 v[40:41], v10 offset:57344
    ds_read_b64_tr_b16 v[42:43], v10 offset:57600
    s_waitcnt lgkmcnt(7)
    v_mfma_f32_32x32x16_bf16 v[64:79], v[44:47], v[252:255], v[64:79]
    ds_read_b64_tr_b16 v[44:45], v11 offset:57344
    ds_read_b64_tr_b16 v[46:47], v11 offset:57600
    s_add_u32 m0, s54, 32768
    s_add_u32 s56, s51, 860288
    s_mov_b32 exec_hi, 0
    buffer_load_dwordx4 v6, s[12:15], s56 offen lds
    s_mov_b32 exec_hi, -1
    s_mov_b64 exec, 0xffff
    ds_write2_b32 v141, v112, v113 offset0:0 offset1:32
    s_mov_b64 exec, -1
    s_mov_b32 vcc_lo, 2863311530
    s_mov_b32 vcc_hi, 2863311530
    v_cndmask_b32 v48, v48, v49, vcc
    v_cndmask_b32 v50, v50, v51, vcc
    v_cndmask_b32 v52, v52, v53, vcc
    v_cndmask_b32 v54, v54, v55, vcc
    v_cndmask_b32 v56, v56, v57, vcc
    v_cndmask_b32 v58, v58, v59, vcc
    v_cndmask_b32 v60, v60, v61, vcc
    v_cndmask_b32 v62, v62, v63, vcc
    s_mov_b32 vcc_lo, 3435973836
    s_mov_b32 vcc_hi, 3435973836
    v_cndmask_b32 v48, v48, v50, vcc
    v_cndmask_b32 v52, v52, v54, vcc
    v_cndmask_b32 v56, v56, v58, vcc
    v_cndmask_b32 v60, v60, v62, vcc
    s_mov_b32 vcc_lo, 4278255360
    s_mov_b32 vcc_hi, 4278255360
    v_cndmask_b32 v48, v48, v52, vcc
    v_cndmask_b32 v56, v56, v60, vcc
    s_mov_b32 vcc_lo, 4294901760
    s_mov_b32 vcc_hi, 4294901760
    v_cndmask_b32 v48, v48, v56, vcc
    s_mov_b32 exec_lo, 0x0F0F0F0F
    s_mov_b32 exec_hi, 0xF0F0F0F0
    ds_write_b32 v141, v48 offset:4
    s_mov_b64 exec, -1
    s_mov_b64 exec, 0xffff
    ds_write2_b32 v7, v20, v21 offset0:0 offset1:16
    s_mov_b64 exec, -1
    s_cmp_lg_u32 s44, 0
    s_cbranch_scc1 p1c1_f_5
    s_waitcnt lgkmcnt(0)
    s_waitcnt vmcnt(3)
    s_barrier
    v_mfma_f32_32x32x16_bf16 v[80:95], v[32:35], v[144:147], 0
    v_mfma_f32_16x16x32_bf16 v[20:23], v[16:19], v[32:35], 0
    ds_read_b64_tr_b16 v[32:33], v8 offset:0
    ds_read_b64_tr_b16 v[34:35], v8 offset:256
    ds_read_b64 v[112:113], v140
    ds_read_b64 v[114:115], v140 offset:1024
    ds_read2st64_b32 v[120:121], v31 offset0:0 offset1:1
    ds_read2st64_b32 v[122:123], v31 offset0:2 offset1:3
    v_readfirstlane_b32 s59, v124
    v_mfma_f32_32x32x16_bf16 v[80:95], v[36:39], v[148:151], v[80:95]
    ds_read_b64_tr_b16 v[36:37], v9 offset:0
    ds_read_b64_tr_b16 v[38:39], v9 offset:256
    s_add_u32 m0, s54, 40960
    s_add_u32 s56, s51, 1032320
    s_mov_b32 exec_hi, 0
    buffer_load_dwordx4 v6, s[12:15], s56 offen lds
    s_mov_b32 exec_hi, -1
    s_waitcnt lgkmcnt(4)
    v_add_f32 v112, v112, v114
    v_add_f32 v113, v113, v115
    v_mul_f32 v112, 0xbb124925, v112
    v_mul_f32 v113, 0x3b124925, v113
    v_fma_f32 v113, -v112, v112, v113
    v_max_f32 v113, 0, v113
    v_add_f32 v113, 0x3727c5ac, v113
    v_rsq_f32 v30, v113
    v_cvt_pk_bf16_f32 v132, v112, v112
    v_lshlrev_b32 v132, 16, v132
    v_mfma_f32_32x32x16_bf16 v[80:95], v[40:43], v[152:155], v[80:95]
    ds_read_b64_tr_b16 v[40:41], v10 offset:0
    ds_read_b64_tr_b16 v[42:43], v10 offset:256
    v_sub_f32 v132, v112, v132
    v_cvt_pk_bf16_f32 v132, v112, v132
    s_mov_b32 vcc_lo, -1
    s_mov_b32 vcc_hi, 0
    v_cndmask_b32 v132, 0, v132, vcc
    v_mov_b32 v133, v132
    v_mul_f32 v29, v113, v30
    v_mul_f32 v27, 0xc0135761, v30
    v_mul_f32 v28, v30, v30
    v_mul_f32 v28, v28, v30
    v_mul_f32 v28, 0xbdd2d3e8, v28
    s_waitcnt lgkmcnt(4)
    v_add_f32 v120, v120, v121
    v_add_f32 v122, v122, v123
    v_add_f32 v120, v120, v122
    v_cvt_pk_bf16_f32 v136, v120, v120
    v_lshlrev_b32 v137, 16, v136
    v_sub_f32 v137, v120, v137
    v_cvt_pk_bf16_f32 v137, v137, v137
    v_mfma_f32_32x32x16_bf16 v[80:95], v[44:47], v[156:159], v[80:95]
    ds_read_b64_tr_b16 v[44:45], v11 offset:0
    ds_read_b64_tr_b16 v[46:47], v11 offset:256
    s_add_u32 m0, s53, 49152
    s_add_u32 s56, s51, 0
    buffer_load_dwordx4 v5, s[12:15], s56 offen lds
    v_mfma_f32_32x32x16_bf16 v[64:79], v[136:139], v[132:135], v[64:79]
    v_mfma_f32_32x32x16_bf16 v[80:95], v[32:35], v[160:163], v[80:95]
    v_mfma_f32_16x16x32_bf16 v[20:23], v[16:19], v[32:35], v[20:23]
    ds_read_b64_tr_b16 v[32:33], v8 offset:8192
    ds_read_b64_tr_b16 v[34:35], v8 offset:8448
    s_nop 7
    v_mul_f32 v112, v64, v64
    v_mul_f32 v113, v65, v65
    v_mul_f32 v114, v66, v66
    v_mul_f32 v115, v67, v67
    v_fma_f32 v112, v112, v28, v27
    v_fma_f32 v113, v113, v28, v27
    v_fma_f32 v114, v114, v28, v27
    v_fma_f32 v115, v115, v28, v27
    v_mul_f32 v112, v64, v112
    v_mul_f32 v113, v65, v113
    v_mul_f32 v114, v66, v114
    v_mul_f32 v115, v67, v115
    s_waitcnt lgkmcnt(6)
    v_mfma_f32_32x32x16_bf16 v[80:95], v[36:39], v[164:167], v[80:95]
    ds_read_b64_tr_b16 v[36:37], v9 offset:8192
    ds_read_b64_tr_b16 v[38:39], v9 offset:8448
    v_exp_f32 v112, v112
    v_exp_f32 v113, v113
    v_exp_f32 v114, v114
    v_exp_f32 v115, v115
    v_fma_f32 v112, v112, v29, v29
    v_fma_f32 v113, v113, v29, v29
    v_fma_f32 v114, v114, v29, v29
    v_fma_f32 v115, v115, v29, v29
    v_rcp_f32 v112, v112
    v_rcp_f32 v113, v113
    v_rcp_f32 v114, v114
    v_rcp_f32 v115, v115
    s_waitcnt lgkmcnt(6)
    v_mfma_f32_32x32x16_bf16 v[80:95], v[40:43], v[168:171], v[80:95]
    ds_read_b64_tr_b16 v[40:41], v10 offset:8192
    ds_read_b64_tr_b16 v[42:43], v10 offset:8448
    v_mul_f32 v64, v64, v112
    v_mul_f32 v65, v65, v113
    v_mul_f32 v66, v66, v114
    v_mul_f32 v67, v67, v115
    v_cvt_pk_bf16_f32 v104, v64, v65
    v_cvt_pk_bf16_f32 v105, v66, v67
    v_mul_f32 v116, v68, v68
    v_mul_f32 v117, v69, v69
    v_mul_f32 v118, v70, v70
    v_mul_f32 v119, v71, v71
    v_fma_f32 v116, v116, v28, v27
    v_fma_f32 v117, v117, v28, v27
    s_waitcnt lgkmcnt(6)
    v_mfma_f32_32x32x16_bf16 v[80:95], v[44:47], v[172:175], v[80:95]
    ds_read_b64_tr_b16 v[44:45], v11 offset:8192
    ds_read_b64_tr_b16 v[46:47], v11 offset:8448
    v_fma_f32 v118, v118, v28, v27
    v_fma_f32 v119, v119, v28, v27
    v_mul_f32 v116, v68, v116
    v_mul_f32 v117, v69, v117
    v_mul_f32 v118, v70, v118
    v_mul_f32 v119, v71, v119
    v_exp_f32 v116, v116
    v_exp_f32 v117, v117
    v_exp_f32 v118, v118
    v_exp_f32 v119, v119
    v_fma_f32 v116, v116, v29, v29
    v_fma_f32 v117, v117, v29, v29
    s_waitcnt vmcnt(3)
    s_barrier
    s_waitcnt lgkmcnt(6)
    v_mfma_f32_32x32x16_bf16 v[80:95], v[32:35], v[176:179], v[80:95]
    v_mfma_f32_16x16x32_bf16 v[20:23], v[16:19], v[32:35], v[20:23]
    ds_read_b64_tr_b16 v[32:33], v8 offset:16384
    ds_read_b64_tr_b16 v[34:35], v8 offset:16640
    v_fma_f32 v118, v118, v29, v29
    v_fma_f32 v119, v119, v29, v29
    v_rcp_f32 v116, v116
    v_rcp_f32 v117, v117
    v_rcp_f32 v118, v118
    v_rcp_f32 v119, v119
    v_mul_f32 v68, v68, v116
    v_mul_f32 v69, v69, v117
    v_mul_f32 v70, v70, v118
    v_mul_f32 v71, v71, v119
    v_cvt_pk_bf16_f32 v106, v68, v69
    v_cvt_pk_bf16_f32 v107, v70, v71
    s_waitcnt lgkmcnt(6)
    v_mfma_f32_32x32x16_bf16 v[80:95], v[36:39], v[180:183], v[80:95]
    ds_read_b64_tr_b16 v[36:37], v9 offset:16384
    ds_read_b64_tr_b16 v[38:39], v9 offset:16640
    s_add_u32 m0, s53, 57344
    s_add_u32 s56, s51, 172032
    buffer_load_dwordx4 v5, s[12:15], s56 offen lds
    v_mul_f32 v112, v72, v72
    v_mul_f32 v113, v73, v73
    v_mul_f32 v114, v74, v74
    v_mul_f32 v115, v75, v75
    v_fma_f32 v112, v112, v28, v27
    v_fma_f32 v113, v113, v28, v27
    v_fma_f32 v114, v114, v28, v27
    v_fma_f32 v115, v115, v28, v27
    v_mul_f32 v112, v72, v112
    v_mul_f32 v113, v73, v113
    v_mul_f32 v114, v74, v114
    v_mul_f32 v115, v75, v115
    s_waitcnt lgkmcnt(6)
    v_mfma_f32_32x32x16_bf16 v[80:95], v[40:43], v[184:187], v[80:95]
    ds_read_b64_tr_b16 v[40:41], v10 offset:16384
    ds_read_b64_tr_b16 v[42:43], v10 offset:16640
    v_exp_f32 v112, v112
    v_exp_f32 v113, v113
    v_exp_f32 v114, v114
    v_exp_f32 v115, v115
    v_fma_f32 v112, v112, v29, v29
    v_fma_f32 v113, v113, v29, v29
    v_fma_f32 v114, v114, v29, v29
    v_fma_f32 v115, v115, v29, v29
    v_rcp_f32 v112, v112
    v_rcp_f32 v113, v113
    v_rcp_f32 v114, v114
    v_rcp_f32 v115, v115
    s_waitcnt lgkmcnt(6)
    v_mfma_f32_32x32x16_bf16 v[80:95], v[44:47], v[188:191], v[80:95]
    ds_read_b64_tr_b16 v[44:45], v11 offset:16384
    ds_read_b64_tr_b16 v[46:47], v11 offset:16640
    v_mul_f32 v72, v72, v112
    v_mul_f32 v73, v73, v113
    v_mul_f32 v74, v74, v114
    v_mul_f32 v75, v75, v115
    v_cvt_pk_bf16_f32 v108, v72, v73
    v_cvt_pk_bf16_f32 v109, v74, v75
    v_mul_f32 v116, v76, v76
    v_mul_f32 v117, v77, v77
    v_mul_f32 v118, v78, v78
    v_mul_f32 v119, v79, v79
    v_fma_f32 v116, v116, v28, v27
    v_fma_f32 v117, v117, v28, v27
    s_waitcnt lgkmcnt(6)
    v_mfma_f32_32x32x16_bf16 v[80:95], v[32:35], v[192:195], v[80:95]
    v_mfma_f32_16x16x32_bf16 v[20:23], v[16:19], v[32:35], v[20:23]
    ds_read_b64_tr_b16 v[32:33], v8 offset:24576
    ds_read_b64_tr_b16 v[34:35], v8 offset:24832
    v_fma_f32 v118, v118, v28, v27
    v_fma_f32 v119, v119, v28, v27
    v_mul_f32 v116, v76, v116
    v_mul_f32 v117, v77, v117
    v_mul_f32 v118, v78, v118
    v_mul_f32 v119, v79, v119
    v_exp_f32 v116, v116
    v_exp_f32 v117, v117
    v_exp_f32 v118, v118
    v_exp_f32 v119, v119
    v_fma_f32 v116, v116, v29, v29
    v_fma_f32 v117, v117, v29, v29
    s_waitcnt lgkmcnt(6)
    v_mfma_f32_32x32x16_bf16 v[80:95], v[36:39], v[196:199], v[80:95]
    ds_read_b64_tr_b16 v[36:37], v9 offset:24576
    ds_read_b64_tr_b16 v[38:39], v9 offset:24832
    s_add_u32 m0, s53, 0
    s_add_u32 s56, s51, 344064
    buffer_load_dwordx4 v5, s[12:15], s56 offen lds
    v_fma_f32 v118, v118, v29, v29
    v_fma_f32 v119, v119, v29, v29
    v_rcp_f32 v116, v116
    v_rcp_f32 v117, v117
    v_rcp_f32 v118, v118
    v_rcp_f32 v119, v119
    v_mul_f32 v76, v76, v116
    v_mul_f32 v77, v77, v117
    v_mul_f32 v78, v78, v118
    v_mul_f32 v79, v79, v119
    v_cvt_pk_bf16_f32 v110, v76, v77
    v_cvt_pk_bf16_f32 v111, v78, v79
    s_waitcnt lgkmcnt(6)
    v_mfma_f32_32x32x16_bf16 v[80:95], v[40:43], v[200:203], v[80:95]
    ds_read_b64_tr_b16 v[40:41], v10 offset:24576
    ds_read_b64_tr_b16 v[42:43], v10 offset:24832
    v_dot2c_f32_bf16 v24, v104, v26
    v_dot2c_f32_bf16 v25, v104, v104
    v_dot2c_f32_bf16 v24, v105, v26
    v_dot2c_f32_bf16 v25, v105, v105
    v_dot2c_f32_bf16 v24, v106, v26
    v_dot2c_f32_bf16 v25, v106, v106
    v_dot2c_f32_bf16 v24, v107, v26
    v_dot2c_f32_bf16 v25, v107, v107
    v_dot2c_f32_bf16 v24, v108, v26
    v_dot2c_f32_bf16 v25, v108, v108
    s_waitcnt lgkmcnt(6)
    v_mfma_f32_32x32x16_bf16 v[80:95], v[44:47], v[204:207], v[80:95]
    ds_read_b64_tr_b16 v[44:45], v11 offset:24576
    ds_read_b64_tr_b16 v[46:47], v11 offset:24832
    v_dot2c_f32_bf16 v24, v109, v26
    v_dot2c_f32_bf16 v25, v109, v109
    v_dot2c_f32_bf16 v24, v110, v26
    v_dot2c_f32_bf16 v25, v110, v110
    v_dot2c_f32_bf16 v24, v111, v26
    v_dot2c_f32_bf16 v25, v111, v111
    s_lshl_b32 s60, s44, 10
    s_add_u32 s60, s60, 160768
    v_add_u32 v124, s60, v143
    v_permlane32_swap_b32 v24, v25
    v_add_f32 v24, v24, v25
    ds_write_b32 v124, v24
    s_waitcnt lgkmcnt(0)
    s_waitcnt vmcnt(3)
    s_barrier
    v_mfma_f32_32x32x16_bf16 v[80:95], v[32:35], v[208:211], v[80:95]
    v_mfma_f32_16x16x32_bf16 v[20:23], v[16:19], v[32:35], v[20:23]
    ds_read_b64_tr_b16 v[32:33], v8 offset:32768
    ds_read_b64_tr_b16 v[34:35], v8 offset:33024
    v_add_u32 v124, 160768, v143
    ds_read2st64_b32 v[126:127], v124 offset0:0 offset1:4
    v_mfma_f32_32x32x16_bf16 v[80:95], v[36:39], v[212:215], v[80:95]
    ds_read_b64_tr_b16 v[36:37], v9 offset:32768
    ds_read_b64_tr_b16 v[38:39], v9 offset:33024
    s_add_u32 m0, s53, 8192
    s_add_u32 s56, s51, 516096
    buffer_load_dwordx4 v5, s[12:15], s56 offen lds
    v_mfma_f32_32x32x16_bf16 v[80:95], v[40:43], v[216:219], v[80:95]
    ds_read_b64_tr_b16 v[40:41], v10 offset:32768
    ds_read_b64_tr_b16 v[42:43], v10 offset:33024
    s_waitcnt lgkmcnt(4)
    v_add_f32 v126, v126, v127
    v_mov_b32 v127, s59
    v_lshlrev_b32 v124, 1, v143
    s_mul_i32 s60, s45, 14
    s_add_u32 s60, s60, s46
    s_lshl_b32 s60, s60, 11
    s_add_u32 s60, s60, 20971520
    s_cmp_lg_u32 s44, 0
    s_cbranch_scc1 zs_f_7
    buffer_store_dwordx2 v[126:127], v124, s[16:19], s60 offen sc1
zs_f_7:
    v_mfma_f32_32x32x16_bf16 v[80:95], v[44:47], v[220:223], v[80:95]
    ds_read_b64_tr_b16 v[44:45], v11 offset:32768
    ds_read_b64_tr_b16 v[46:47], v11 offset:33024
    v_mfma_f32_32x32x16_bf16 v[80:95], v[32:35], v[224:227], v[80:95]
    v_mfma_f32_16x16x32_bf16 v[20:23], v[16:19], v[32:35], v[20:23]
    ds_read_b64_tr_b16 v[32:33], v8 offset:40960
    ds_read_b64_tr_b16 v[34:35], v8 offset:41216
    v_and_b32 v142, 31, v1
    s_waitcnt lgkmcnt(6)
    v_mfma_f32_32x32x16_bf16 v[80:95], v[36:39], v[228:231], v[80:95]
    ds_read_b64_tr_b16 v[36:37], v9 offset:40960
    ds_read_b64_tr_b16 v[38:39], v9 offset:41216
    s_add_u32 m0, s53, 16384
    s_add_u32 s56, s51, 688128
    buffer_load_dwordx4 v5, s[12:15], s56 offen lds
    v_lshrrev_b32 v124, 4, v142
    v_and_b32 v142, 15, v142
    s_waitcnt lgkmcnt(6)
    v_mfma_f32_32x32x16_bf16 v[80:95], v[40:43], v[232:235], v[80:95]
    ds_read_b64_tr_b16 v[40:41], v10 offset:40960
    ds_read_b64_tr_b16 v[42:43], v10 offset:41216
    v_lshlrev_b32 v142, 4, v142
    s_waitcnt lgkmcnt(6)
    v_mfma_f32_32x32x16_bf16 v[80:95], v[44:47], v[236:239], v[80:95]
    ds_read_b64_tr_b16 v[44:45], v11 offset:40960
    ds_read_b64_tr_b16 v[46:47], v11 offset:41216
    v_lshl_add_u32 v142, v124, 3, v142
    v_lshrrev_b32 v124, 5, v1
    s_waitcnt vmcnt(4)
    s_barrier
    s_waitcnt lgkmcnt(6)
    v_mfma_f32_32x32x16_bf16 v[80:95], v[32:35], v[240:243], v[80:95]
    v_mfma_f32_16x16x32_bf16 v[20:23], v[16:19], v[32:35], v[20:23]
    ds_read_b64_tr_b16 v[32:33], v12 offset:49152
    ds_read_b64_tr_b16 v[34:35], v12 offset:49664
    v_mul_u32_u24 v124, 14336, v124
    s_waitcnt lgkmcnt(6)
    v_mfma_f32_32x32x16_bf16 v[80:95], v[36:39], v[244:247], v[80:95]
    ds_read_b64_tr_b16 v[36:37], v13 offset:49152
    ds_read_b64_tr_b16 v[38:39], v13 offset:49664
    s_add_u32 m0, s53, 24576
    s_add_u32 s56, s51, 860160
    buffer_load_dwordx4 v5, s[12:15], s56 offen lds
    v_add_u32 v142, v142, v124
    s_mul_i32 s61, s45, 28672
    s_waitcnt lgkmcnt(6)
    v_mfma_f32_32x32x16_bf16 v[80:95], v[40:43], v[248:251], v[80:95]
    ds_read_b64_tr_b16 v[40:41], v14 offset:49152
    ds_read_b64_tr_b16 v[42:43], v14 offset:49664
    s_lshl_b32 s60, s42, 8
    s_waitcnt lgkmcnt(6)
    v_mfma_f32_32x32x16_bf16 v[80:95], v[44:47], v[252:255], v[80:95]
    ds_read_b64_tr_b16 v[44:45], v15 offset:49152
    ds_read_b64_tr_b16 v[46:47], v15 offset:49664
    s_add_u32 s61, s61, s60
    s_add_u32 s61, s61, 20971520
    s_mov_b64 exec, 0xffff
    ds_write2_b32 v7, v20, v21 offset0:0 offset1:16
    s_mov_b64 exec, -1
    s_waitcnt lgkmcnt(0)
    s_branch p1j_f_6
p1c1_f_5:
    s_waitcnt lgkmcnt(0)
    s_waitcnt vmcnt(3)
    s_barrier
    ds_read_b64 v[112:113], v140
    ds_read_b64 v[114:115], v140 offset:1024
    ds_read2st64_b32 v[120:121], v31 offset0:0 offset1:1
    ds_read2st64_b32 v[122:123], v31 offset0:2 offset1:3
    v_readfirstlane_b32 s59, v124
    s_add_u32 m0, s54, 40960
    s_add_u32 s56, s51, 1032320
    s_mov_b32 exec_hi, 0
    buffer_load_dwordx4 v6, s[12:15], s56 offen lds
    s_mov_b32 exec_hi, -1
    s_waitcnt lgkmcnt(2)
    v_add_f32 v112, v112, v114
    v_add_f32 v113, v113, v115
    v_mul_f32 v112, 0xbb124925, v112
    v_mul_f32 v113, 0x3b124925, v113
    v_fma_f32 v113, -v112, v112, v113
    v_max_f32 v113, 0, v113
    v_add_f32 v113, 0x3727c5ac, v113
    v_rsq_f32 v30, v113
    v_cvt_pk_bf16_f32 v132, v112, v112
    v_lshlrev_b32 v132, 16, v132
    v_sub_f32 v132, v112, v132
    v_cvt_pk_bf16_f32 v132, v112, v132
    s_mov_b32 vcc_lo, -1
    s_mov_b32 vcc_hi, 0
    v_cndmask_b32 v132, 0, v132, vcc
    v_mov_b32 v133, v132
    v_mul_f32 v29, v113, v30
    v_mul_f32 v27, 0xc0135761, v30
    v_mul_f32 v28, v30, v30
    v_mul_f32 v28, v28, v30
    v_mul_f32 v28, 0xbdd2d3e8, v28
    s_waitcnt lgkmcnt(0)
    v_add_f32 v120, v120, v121
    v_add_f32 v122, v122, v123
    v_add_f32 v120, v120, v122
    v_cvt_pk_bf16_f32 v136, v120, v120
    v_lshlrev_b32 v137, 16, v136
    v_sub_f32 v137, v120, v137
    v_cvt_pk_bf16_f32 v137, v137, v137
    s_add_u32 m0, s53, 49152
    s_add_u32 s56, s51, 0
    buffer_load_dwordx4 v5, s[12:15], s56 offen lds
    v_mfma_f32_32x32x16_bf16 v[64:79], v[136:139], v[132:135], v[64:79]
    s_nop 11
    v_mul_f32 v112, v64, v64
    v_mul_f32 v113, v65, v65
    v_mul_f32 v114, v66, v66
    v_mul_f32 v115, v67, v67
    v_fma_f32 v112, v112, v28, v27
    v_fma_f32 v113, v113, v28, v27
    v_fma_f32 v114, v114, v28, v27
    v_fma_f32 v115, v115, v28, v27
    v_mul_f32 v112, v64, v112
    v_mul_f32 v113, v65, v113
    v_mul_f32 v114, v66, v114
    v_mul_f32 v115, v67, v115
    v_exp_f32 v112, v112
    v_exp_f32 v113, v113
    v_exp_f32 v114, v114
    v_exp_f32 v115, v115
    v_fma_f32 v112, v112, v29, v29
    v_fma_f32 v113, v113, v29, v29
    v_fma_f32 v114, v114, v29, v29
    v_fma_f32 v115, v115, v29, v29
    v_rcp_f32 v112, v112
    v_rcp_f32 v113, v113
    v_rcp_f32 v114, v114
    v_rcp_f32 v115, v115
    v_mul_f32 v64, v64, v112
    v_mul_f32 v65, v65, v113
    v_mul_f32 v66, v66, v114
    v_mul_f32 v67, v67, v115
    v_cvt_pk_bf16_f32 v104, v64, v65
    v_cvt_pk_bf16_f32 v105, v66, v67
    v_mul_f32 v116, v68, v68
    v_mul_f32 v117, v69, v69
    v_mul_f32 v118, v70, v70
    v_mul_f32 v119, v71, v71
    v_fma_f32 v116, v116, v28, v27
    v_fma_f32 v117, v117, v28, v27
    v_fma_f32 v118, v118, v28, v27
    v_fma_f32 v119, v119, v28, v27
    v_mul_f32 v116, v68, v116
    v_mul_f32 v117, v69, v117
    v_mul_f32 v118, v70, v118
    v_mul_f32 v119, v71, v119
    v_exp_f32 v116, v116
    v_exp_f32 v117, v117
    v_exp_f32 v118, v118
    v_exp_f32 v119, v119
    v_fma_f32 v116, v116, v29, v29
    v_fma_f32 v117, v117, v29, v29
    s_waitcnt vmcnt(3)
    s_barrier
    v_fma_f32 v118, v118, v29, v29
    v_fma_f32 v119, v119, v29, v29
    v_rcp_f32 v116, v116
    v_rcp_f32 v117, v117
    v_rcp_f32 v118, v118
    v_rcp_f32 v119, v119
    v_mul_f32 v68, v68, v116
    v_mul_f32 v69, v69, v117
    v_mul_f32 v70, v70, v118
    v_mul_f32 v71, v71, v119
    v_cvt_pk_bf16_f32 v106, v68, v69
    v_cvt_pk_bf16_f32 v107, v70, v71
    s_add_u32 m0, s53, 57344
    s_add_u32 s56, s51, 172032
    buffer_load_dwordx4 v5, s[12:15], s56 offen lds
    v_mul_f32 v112, v72, v72
    v_mul_f32 v113, v73, v73
    v_mul_f32 v114, v74, v74
    v_mul_f32 v115, v75, v75
    v_fma_f32 v112, v112, v28, v27
    v_fma_f32 v113, v113, v28, v27
    v_fma_f32 v114, v114, v28, v27
    v_fma_f32 v115, v115, v28, v27
    v_mul_f32 v112, v72, v112
    v_mul_f32 v113, v73, v113
    v_mul_f32 v114, v74, v114
    v_mul_f32 v115, v75, v115
    v_exp_f32 v112, v112
    v_exp_f32 v113, v113
    v_exp_f32 v114, v114
    v_exp_f32 v115, v115
    v_fma_f32 v112, v112, v29, v29
    v_fma_f32 v113, v113, v29, v29
    v_fma_f32 v114, v114, v29, v29
    v_fma_f32 v115, v115, v29, v29
    v_rcp_f32 v112, v112
    v_rcp_f32 v113, v113
    v_rcp_f32 v114, v114
    v_rcp_f32 v115, v115
    v_mul_f32 v72, v72, v112
    v_mul_f32 v73, v73, v113
    v_mul_f32 v74, v74, v114
    v_mul_f32 v75, v75, v115
    v_cvt_pk_bf16_f32 v108, v72, v73
    v_cvt_pk_bf16_f32 v109, v74, v75
    v_mul_f32 v116, v76, v76
    v_mul_f32 v117, v77, v77
    v_mul_f32 v118, v78, v78
    v_mul_f32 v119, v79, v79
    v_fma_f32 v116, v116, v28, v27
    v_fma_f32 v117, v117, v28, v27
    v_fma_f32 v118, v118, v28, v27
    v_fma_f32 v119, v119, v28, v27
    v_mul_f32 v116, v76, v116
    v_mul_f32 v117, v77, v117
    v_mul_f32 v118, v78, v118
    v_mul_f32 v119, v79, v119
    v_exp_f32 v116, v116
    v_exp_f32 v117, v117
    v_exp_f32 v118, v118
    v_exp_f32 v119, v119
    v_fma_f32 v116, v116, v29, v29
    v_fma_f32 v117, v117, v29, v29
    s_add_u32 m0, s53, 0
    s_add_u32 s56, s51, 344064
    buffer_load_dwordx4 v5, s[12:15], s56 offen lds
    v_fma_f32 v118, v118, v29, v29
    v_fma_f32 v119, v119, v29, v29
    v_rcp_f32 v116, v116
    v_rcp_f32 v117, v117
    v_rcp_f32 v118, v118
    v_rcp_f32 v119, v119
    v_mul_f32 v76, v76, v116
    v_mul_f32 v77, v77, v117
    v_mul_f32 v78, v78, v118
    v_mul_f32 v79, v79, v119
    v_cvt_pk_bf16_f32 v110, v76, v77
    v_cvt_pk_bf16_f32 v111, v78, v79
    v_dot2c_f32_bf16 v24, v104, v26
    v_dot2c_f32_bf16 v25, v104, v104
    v_dot2c_f32_bf16 v24, v105, v26
    v_dot2c_f32_bf16 v25, v105, v105
    v_dot2c_f32_bf16 v24, v106, v26
    v_dot2c_f32_bf16 v25, v106, v106
    v_dot2c_f32_bf16 v24, v107, v26
    v_dot2c_f32_bf16 v25, v107, v107
    v_dot2c_f32_bf16 v24, v108, v26
    v_dot2c_f32_bf16 v25, v108, v108
    v_dot2c_f32_bf16 v24, v109, v26
    v_dot2c_f32_bf16 v25, v109, v109
    v_dot2c_f32_bf16 v24, v110, v26
    v_dot2c_f32_bf16 v25, v110, v110
    v_dot2c_f32_bf16 v24, v111, v26
    v_dot2c_f32_bf16 v25, v111, v111
    s_lshl_b32 s60, s44, 10
    s_add_u32 s60, s60, 160768
    v_add_u32 v124, s60, v143
    v_permlane32_swap_b32 v24, v25
    v_add_f32 v24, v24, v25
    ds_write_b32 v124, v24
    s_waitcnt lgkmcnt(0)
    s_waitcnt vmcnt(3)
    s_barrier
    v_add_u32 v124, 160768, v143
    ds_read2st64_b32 v[126:127], v124 offset0:0 offset1:4
    s_add_u32 m0, s53, 8192
    s_add_u32 s56, s51, 516096
    buffer_load_dwordx4 v5, s[12:15], s56 offen lds
    s_waitcnt lgkmcnt(0)
    v_add_f32 v126, v126, v127
    v_mov_b32 v127, s59
    v_lshlrev_b32 v124, 1, v143
    s_mul_i32 s60, s45, 14
    s_add_u32 s60, s60, s46
    s_lshl_b32 s60, s60, 11
    s_add_u32 s60, s60, 20971520
    s_cmp_lg_u32 s44, 0
    s_cbranch_scc1 zs_f_8
    buffer_store_dwordx2 v[126:127], v124, s[16:19], s60 offen sc1
zs_f_8:
    v_and_b32 v142, 31, v1
    s_add_u32 m0, s53, 16384
    s_add_u32 s56, s51, 688128
    buffer_load_dwordx4 v5, s[12:15], s56 offen lds
    v_lshrrev_b32 v124, 4, v142
    v_and_b32 v142, 15, v142
    v_lshlrev_b32 v142, 4, v142
    v_lshl_add_u32 v142, v124, 3, v142
    v_lshrrev_b32 v124, 5, v1
    s_waitcnt vmcnt(4)
    s_barrier
    ds_read_b64_tr_b16 v[32:33], v12 offset:49152
    ds_read_b64_tr_b16 v[34:35], v12 offset:49664
    v_mul_u32_u24 v124, 14336, v124
    ds_read_b64_tr_b16 v[36:37], v13 offset:49152
    ds_read_b64_tr_b16 v[38:39], v13 offset:49664
    s_add_u32 m0, s53, 24576
    s_add_u32 s56, s51, 860160
    buffer_load_dwordx4 v5, s[12:15], s56 offen lds
    v_add_u32 v142, v142, v124
    s_mul_i32 s61, s45, 28672
    ds_read_b64_tr_b16 v[40:41], v14 offset:49152
    ds_read_b64_tr_b16 v[42:43], v14 offset:49664
    s_lshl_b32 s60, s42, 8
    ds_read_b64_tr_b16 v[44:45], v15 offset:49152
    ds_read_b64_tr_b16 v[46:47], v15 offset:49664
    s_add_u32 s61, s61, s60
    s_add_u32 s61, s61, 20971520
    s_waitcnt lgkmcnt(0)
    s_nop 7
p1j_f_6:
    s_waitcnt vmcnt(3)
    s_barrier
    v_mfma_f32_32x32x16_bf16 v[48:63], v[32:35], v[144:147], 0
    s_nop 2
    v_mfma_f32_16x16x32_bf16 v[20:23], v[16:19], v[32:35], 0
    ds_read_b64_tr_b16 v[32:33], v12 offset:57344
    ds_read_b64_tr_b16 v[34:35], v12 offset:57856
    ds_read2st64_b32 v[120:121], v31 offset0:0 offset1:1
    ds_read2st64_b32 v[122:123], v31 offset0:2 offset1:3
    v_mfma_f32_32x32x16_bf16 v[48:63], v[36:39], v[148:151], v[48:63]
    ds_read_b64_tr_b16 v[36:37], v13 offset:57344
    ds_read_b64_tr_b16 v[38:39], v13 offset:57856
    s_add_u32 m0, s53, 32768
    s_add_u32 s56, s51, 1032192
    buffer_load_dwordx4 v5, s[12:15], s56 offen lds
    v_and_b32 v112, 31, v1
    s_lshl_b32 s55, s43, 5
    v_add_u32 v112, s55, v112
    v_mul_u32_u24 v112, 80, v112
    v_lshrrev_b32 v113, 5, v1
    v_lshlrev_b32 v113, 3, v113
    v_add_u32 v112, v112, v113
    v_add_u32 v119, 149504, v112
    s_cmp_eq_u32 s44, 0
    s_cbranch_scc1 q2a_f_9
    v_lshlrev_b32 v119, 3, v1
    v_add_u32 v119, 32768, v119
q2a_f_9:
    v_lshrrev_b32 v112, 2, v1
    s_lshl_b32 s55, s42, 4
    v_add_u32 v112, s55, v112
    v_mul_u32_u24 v112, 80, v112
    v_and_b32 v113, 3, v1
    v_lshlrev_b32 v113, 4, v113
    v_add_u32 v112, v112, v113
    v_add_u32 v118, 149504, v112
    v_mfma_f32_32x32x16_bf16 v[48:63], v[40:43], v[152:155], v[48:63]
    ds_read_b64_tr_b16 v[40:41], v14 offset:57344
    ds_read_b64_tr_b16 v[42:43], v14 offset:57856
    s_waitcnt lgkmcnt(4)
    v_add_f32 v120, v120, v121
    v_add_f32 v122, v122, v123
    v_add_f32 v120, v120, v122
    v_cvt_pk_bf16_f32 v136, v120, v120
    v_lshlrev_b32 v137, 16, v136
    v_sub_f32 v137, v120, v137
    v_cvt_pk_bf16_f32 v137, v137, v137
    buffer_load_dwordx2 v[64:65], v142, s[16:19], s61 offen offset:0 sc1
    v_lshrrev_b32 v124, 3, v1
    v_lshrrev_b32 v125, 4, v1
    v_and_b32 v126, 7, v1
    v_lshlrev_b32 v2, 12, v124
    v_xor_b32 v127, v126, v125
    v_lshlrev_b32 v127, 4, v127
    v_add_u32 v3, 31744, v2
    v_add_u32 v2, v2, v127
    v_xor_b32 v127, 64, v127
    v_add_u32 v3, v3, v127
    s_lshl_b32 s48, s42, 4
    s_add_u32 s48, s48, s47
    s_lshl_b32 s48, s48, 12
    s_mov_b32 s22, 8388608
    s_mov_b32 s23, 0x20000
    v_mfma_f32_32x32x16_bf16 v[48:63], v[44:47], v[156:159], v[48:63]
    ds_read_b64_tr_b16 v[44:45], v15 offset:57344
    ds_read_b64_tr_b16 v[46:47], v15 offset:57856
    v_mfma_f32_32x32x16_bf16 v[80:95], v[136:139], v[132:135], v[80:95]
    buffer_load_dwordx2 v[66:67], v142, s[16:19], s61 offen offset:2048 sc1
    v_mfma_f32_32x32x16_bf16 v[48:63], v[32:35], v[160:163], v[48:63]
    v_mfma_f32_16x16x32_bf16 v[20:23], v[16:19], v[32:35], v[20:23]
    ds_read_b64_tr_b16 v[32:33], v12 offset:0
    ds_read_b64_tr_b16 v[34:35], v12 offset:512
    s_nop 6
    v_mul_f32 v80, v80, v30
    v_mul_f32 v81, v81, v30
    v_mul_f32 v82, v82, v30
    v_mul_f32 v83, v83, v30
    v_cvt_pk_bf16_f32 v96, v80, v81
    v_cvt_pk_bf16_f32 v97, v82, v83
    v_mul_f32 v84, v84, v30
    v_mul_f32 v85, v85, v30
    s_add_u32 s61, s61, 4096
    buffer_load_dwordx2 v[68:69], v142, s[16:19], s61 offen offset:0 sc1
    s_waitcnt lgkmcnt(6)
    v_mfma_f32_32x32x16_bf16 v[48:63], v[36:39], v[164:167], v[48:63]
    ds_read_b64_tr_b16 v[36:37], v13 offset:0
    ds_read_b64_tr_b16 v[38:39], v13 offset:512
    s_add_u32 m0, s53, 40960
    s_add_u32 s56, s50, 0
    buffer_load_dwordx4 v4, s[8:11], s56 offen lds
    v_mul_f32 v86, v86, v30
    v_mul_f32 v87, v87, v30
    v_cvt_pk_bf16_f32 v98, v84, v85
    v_cvt_pk_bf16_f32 v99, v86, v87
    v_mul_f32 v88, v88, v30
    v_mul_f32 v89, v89, v30
    v_mul_f32 v90, v90, v30
    v_mul_f32 v91, v91, v30
    buffer_load_dwordx2 v[70:71], v142, s[16:19], s61 offen offset:2048 sc1
    s_waitcnt lgkmcnt(6)
    v_mfma_f32_32x32x16_bf16 v[48:63], v[40:43], v[168:171], v[48:63]
    ds_read_b64_tr_b16 v[40:41], v14 offset:0
    ds_read_b64_tr_b16 v[42:43], v14 offset:512
    v_cvt_pk_bf16_f32 v100, v88, v89
    v_cvt_pk_bf16_f32 v101, v90, v91
    v_mul_f32 v92, v92, v30
    v_mul_f32 v93, v93, v30
    v_mul_f32 v94, v94, v30
    v_mul_f32 v95, v95, v30
    v_cvt_pk_bf16_f32 v102, v92, v93
    v_cvt_pk_bf16_f32 v103, v94, v95
    s_add_u32 s61, s61, 4096
    buffer_load_dwordx2 v[72:73], v142, s[16:19], s61 offen offset:0 sc1
    s_waitcnt lgkmcnt(6)
    v_mfma_f32_32x32x16_bf16 v[48:63], v[44:47], v[172:175], v[48:63]
    ds_read_b64_tr_b16 v[44:45], v15 offset:0
    ds_read_b64_tr_b16 v[46:47], v15 offset:512
    ds_write_b64 v119, v[96:97] offset:0
    ds_write_b64 v119, v[98:99] offset:16
    ds_write_b64 v119, v[100:101] offset:32
    ds_write_b64 v119, v[102:103] offset:48
    buffer_load_dwordx2 v[74:75], v142, s[16:19], s61 offen offset:2048 sc1
    s_add_u32 s61, s61, 4096
    buffer_load_dwordx2 v[76:77], v142, s[16:19], s61 offen offset:0 sc1
    s_sub_u32 s61, s61, 12288
    s_waitcnt lgkmcnt(0)
    s_waitcnt vmcnt(10)
    s_barrier
    v_mfma_f32_32x32x16_bf16 v[48:63], v[32:35], v[176:179], v[48:63]
    v_mfma_f32_16x16x32_bf16 v[20:23], v[16:19], v[32:35], v[20:23]
    ds_read_b64_tr_b16 v[32:33], v12 offset:8192
    ds_read_b64_tr_b16 v[34:35], v12 offset:8704
    ds_read_b128 v[112:115], v118 offset:0
    v_mfma_f32_32x32x16_bf16 v[48:63], v[36:39], v[180:183], v[48:63]
    ds_read_b64_tr_b16 v[36:37], v13 offset:8192
    ds_read_b64_tr_b16 v[38:39], v13 offset:8704
    s_add_u32 m0, s53, 49152
    s_add_u32 s56, s50, 229376
    buffer_load_dwordx4 v4, s[8:11], s56 offen lds
    s_add_u32 m0, s52, 32768
    s_add_u32 s55, s48, 256
    buffer_load_dwordx4 v2, s[20:23], s55 offen offset:0 lds
    buffer_load_dwordx4 v3, s[20:23], s55 offen offset:1024 lds
    v_mfma_f32_32x32x16_bf16 v[48:63], v[40:43], v[184:187], v[48:63]
    ds_read_b64_tr_b16 v[40:41], v14 offset:8192
    ds_read_b64_tr_b16 v[42:43], v14 offset:8704
    s_lshl_b32 s58, s42, 4
    s_add_u32 s58, s58, s47
    s_mul_i32 s58, s58, 2688
    s_mul_i32 s57, s46, 192
    s_add_u32 s58, s58, s57
    s_add_u32 s58, s58, 8388736
    s_waitcnt lgkmcnt(4)
    buffer_store_dwordx4 v[112:115], v6, s[16:19], s58 offen sc1
    v_mfma_f32_32x32x16_bf16 v[48:63], v[44:47], v[188:191], v[48:63]
    ds_read_b64_tr_b16 v[44:45], v15 offset:8192
    ds_read_b64_tr_b16 v[46:47], v15 offset:8704
    v_mfma_f32_32x32x16_bf16 v[48:63], v[32:35], v[192:195], v[48:63]
    v_mfma_f32_16x16x32_bf16 v[20:23], v[16:19], v[32:35], v[20:23]
    ds_read_b64_tr_b16 v[32:33], v12 offset:16384
    ds_read_b64_tr_b16 v[34:35], v12 offset:16896
    s_waitcnt lgkmcnt(6)
    v_mfma_f32_32x32x16_bf16 v[48:63], v[36:39], v[196:199], v[48:63]
    ds_read_b64_tr_b16 v[36:37], v13 offset:16384
    ds_read_b64_tr_b16 v[38:39], v13 offset:16896
    s_add_u32 m0, s53, 57344
    s_add_u32 s56, s50, 458752
    buffer_load_dwordx4 v4, s[8:11], s56 offen lds
    s_add_u32 m0, s52, 49152
    s_add_u32 s55, s48, 384
    buffer_load_dwordx4 v2, s[20:23], s55 offen offset:0 lds
    buffer_load_dwordx4 v3, s[20:23], s55 offen offset:1024 lds
    s_waitcnt lgkmcnt(6)
    v_mfma_f32_32x32x16_bf16 v[48:63], v[40:43], v[200:203], v[48:63]
    ds_read_b64_tr_b16 v[40:41], v14 offset:16384
    ds_read_b64_tr_b16 v[42:43], v14 offset:16896
    s_waitcnt lgkmcnt(6)
    v_mfma_f32_32x32x16_bf16 v[48:63], v[44:47], v[204:207], v[48:63]
    ds_read_b64_tr_b16 v[44:45], v15 offset:16384
    ds_read_b64_tr_b16 v[46:47], v15 offset:16896
    s_waitcnt vmcnt(16)
    s_barrier
    s_waitcnt lgkmcnt(6)
    v_mfma_f32_32x32x16_bf16 v[48:63], v[32:35], v[208:211], v[48:63]
    v_mfma_f32_16x16x32_bf16 v[20:23], v[16:19], v[32:35], v[20:23]
    ds_read_b64_tr_b16 v[32:33], v12 offset:24576
    ds_read_b64_tr_b16 v[34:35], v12 offset:25088
    s_waitcnt vmcnt(7)
    s_mov_b32 s60, 0
pc_f_10_chk:
    v_cmp_ne_u32 vcc, s59, v65
    s_mov_b64 s[62:63], vcc
    v_cmp_ne_u32 vcc, s59, v67
    s_or_b64 s[62:63], s[62:63], vcc
    v_cmp_ne_u32 vcc, s59, v69
    s_or_b64 s[62:63], s[62:63], vcc
    v_cmp_ne_u32 vcc, s59, v71
    s_or_b64 s[62:63], s[62:63], vcc
    v_cmp_ne_u32 vcc, s59, v73
    s_or_b64 s[62:63], s[62:63], vcc
    v_cmp_ne_u32 vcc, s59, v75
    s_or_b64 s[62:63], s[62:63], vcc
    v_cmp_ne_u32 vcc, s59, v77
    s_or_b64 s[62:63], s[62:63], vcc
    s_cmp_eq_u64 s[62:63], 0
    s_cbranch_scc1 pc_f_10_ok
    s_add_u32 s60, s60, 1
    s_cmp_ge_u32 s60, 0x10000
    s_cbranch_scc1 pc_f_10_ok
    buffer_load_dwordx2 v[64:65], v142, s[16:19], s61 offen offset:0 sc1
    buffer_load_dwordx2 v[66:67], v142, s[16:19], s61 offen offset:2048 sc1
    s_add_u32 s61, s61, 4096
    buffer_load_dwordx2 v[68:69], v142, s[16:19], s61 offen offset:0 sc1
    buffer_load_dwordx2 v[70:71], v142, s[16:19], s61 offen offset:2048 sc1
    s_add_u32 s61, s61, 4096
    buffer_load_dwordx2 v[72:73], v142, s[16:19], s61 offen offset:0 sc1
    buffer_load_dwordx2 v[74:75], v142, s[16:19], s61 offen offset:2048 sc1
    s_add_u32 s61, s61, 4096
    buffer_load_dwordx2 v[76:77], v142, s[16:19], s61 offen offset:0 sc1
    s_sub_u32 s61, s61, 12288
    s_waitcnt vmcnt(0)
    s_branch pc_f_10_chk
pc_f_10_ok:
    s_waitcnt lgkmcnt(6)
    v_mfma_f32_32x32x16_bf16 v[48:63], v[36:39], v[212:215], v[48:63]
    ds_read_b64_tr_b16 v[36:37], v13 offset:24576
    ds_read_b64_tr_b16 v[38:39], v13 offset:25088
    s_add_u32 m0, s53, 0
    s_add_u32 s56, s50, 688128
    buffer_load_dwordx4 v4, s[8:11], s56 offen lds
    v_add_f32 v64, v64, v66
    v_add_f32 v68, v68, v70
    v_add_f32 v72, v72, v74
    v_add_f32 v64, v64, v68
    v_add_f32 v72, v72, v76
    v_add_f32 v64, v64, v72
    s_waitcnt lgkmcnt(6)
    v_mfma_f32_32x32x16_bf16 v[48:63], v[40:43], v[216:219], v[48:63]
    ds_read_b64_tr_b16 v[40:41], v14 offset:24576
    ds_read_b64_tr_b16 v[42:43], v14 offset:25088
    v_and_b32 v66, 31, v1
    v_mov_b32 v65, v64
    v_lshrrev_b32 v67, 4, v66
    v_and_b32 v66, 15, v66
    v_permlane32_swap_b32 v64, v65
    v_lshlrev_b32 v66, 3, v66
    s_waitcnt lgkmcnt(6)
    v_mfma_f32_32x32x16_bf16 v[48:63], v[44:47], v[220:223], v[48:63]
    ds_read_b64_tr_b16 v[44:45], v15 offset:24576
    ds_read_b64_tr_b16 v[46:47], v15 offset:25088
    v_lshl_add_u32 v66, v67, 2, v66
    v_add_f32 v64, v64, v65
    s_lshl_b32 s60, s42, 7
    s_add_u32 s60, s60, 160768
    v_add_u32 v66, s60, v66
    s_mov_b32 exec_hi, 0
    ds_write_b32 v66, v64
    s_mov_b32 exec_hi, -1
    s_waitcnt lgkmcnt(0)
    s_barrier
    v_mfma_f32_32x32x16_bf16 v[48:63], v[32:35], v[224:227], v[48:63]
    v_mfma_f32_16x16x32_bf16 v[20:23], v[16:19], v[32:35], v[20:23]
    ds_read_b64_tr_b16 v[32:33], v12 offset:32768
    ds_read_b64_tr_b16 v[34:35], v12 offset:33280
    v_add_u32 v66, 11264, v140
    ds_read_b64 v[64:65], v66
    v_mfma_f32_32x32x16_bf16 v[48:63], v[36:39], v[228:231], v[48:63]
    ds_read_b64_tr_b16 v[36:37], v13 offset:32768
    ds_read_b64_tr_b16 v[38:39], v13 offset:33280
    s_add_u32 m0, s53, 8192
    s_add_u32 s56, s50, 917504
    buffer_load_dwordx4 v4, s[8:11], s56 offen lds
    s_waitcnt lgkmcnt(2)
    v_mul_f32 v64, 0x3a924925, v64
    v_mul_f32 v65, 0x3a924925, v65
    v_fma_f32 v65, -v64, v64, v65
    v_max_f32 v65, 0, v65
    v_add_f32 v65, 0x3727c5ac, v65
    v_rsq_f32 v68, v65
    v_subrev_u32 v8, 131072, v128
    v_mul_f32 v69, v64, v68
    v_sub_f32 v69, 0, v69
    v_mfma_f32_32x32x16_bf16 v[48:63], v[40:43], v[232:235], v[48:63]
    ds_read_b64_tr_b16 v[40:41], v14 offset:32768
    ds_read_b64_tr_b16 v[42:43], v14 offset:33280
    v_lshlrev_b32 v70, 16, v104
    v_lshlrev_b32 v71, 16, v105
    v_lshlrev_b32 v72, 16, v106
    v_lshlrev_b32 v73, 16, v107
    v_and_b32 v74, 0xffff0000, v104
    v_and_b32 v75, 0xffff0000, v105
    v_mfma_f32_32x32x16_bf16 v[48:63], v[44:47], v[236:239], v[48:63]
    ds_read_b64_tr_b16 v[44:45], v15 offset:32768
    ds_read_b64_tr_b16 v[46:47], v15 offset:33280
    v_and_b32 v76, 0xffff0000, v106
    v_and_b32 v77, 0xffff0000, v107
    v_fma_f32 v70, v70, v68, v69
    v_fma_f32 v71, v71, v68, v69
    v_fma_f32 v72, v72, v68, v69
    v_fma_f32 v73, v73, v68, v69
    v_fma_f32 v74, v74, v68, v69
    s_barrier
    v_mfma_f32_32x32x16_bf16 v[48:63], v[32:35], v[240:243], v[48:63]
    v_mfma_f32_16x16x32_bf16 v[20:23], v[16:19], v[32:35], v[20:23]
    ds_read_b64_tr_b16 v[32:33], v12 offset:40960
    ds_read_b64_tr_b16 v[34:35], v12 offset:41472
    v_fma_f32 v75, v75, v68, v69
    v_fma_f32 v76, v76, v68, v69
    v_fma_f32 v77, v77, v68, v69
    v_cvt_pk_bf16_f32 v104, v70, v74
    v_cvt_pk_bf16_f32 v105, v71, v75
    v_cvt_pk_bf16_f32 v106, v72, v76
    v_cvt_pk_bf16_f32 v107, v73, v77
    s_waitcnt lgkmcnt(6)
    v_mfma_f32_32x32x16_bf16 v[48:63], v[36:39], v[244:247], v[48:63]
    ds_read_b64_tr_b16 v[36:37], v13 offset:40960
    ds_read_b64_tr_b16 v[38:39], v13 offset:41472
    s_add_u32 m0, s53, 16384
    s_add_u32 s56, s50, 1146880
    buffer_load_dwordx4 v4, s[8:11], s56 offen lds
    v_lshlrev_b32 v70, 16, v108
    v_lshlrev_b32 v71, 16, v109
    v_lshlrev_b32 v72, 16, v110
    v_lshlrev_b32 v73, 16, v111
    v_and_b32 v74, 0xffff0000, v108
    v_and_b32 v75, 0xffff0000, v109
    s_waitcnt lgkmcnt(6)
    v_mfma_f32_32x32x16_bf16 v[48:63], v[40:43], v[248:251], v[48:63]
    ds_read_b64_tr_b16 v[40:41], v14 offset:40960
    ds_read_b64_tr_b16 v[42:43], v14 offset:41472
    v_and_b32 v76, 0xffff0000, v110
    v_and_b32 v77, 0xffff0000, v111
    v_fma_f32 v70, v70, v68, v69
    v_fma_f32 v71, v71, v68, v69
    v_fma_f32 v72, v72, v68, v69
    v_fma_f32 v73, v73, v68, v69
    v_fma_f32 v74, v74, v68, v69
    s_waitcnt lgkmcnt(6)
    v_mfma_f32_32x32x16_bf16 v[48:63], v[44:47], v[252:255], v[48:63]
    ds_read_b64_tr_b16 v[44:45], v15 offset:40960
    ds_read_b64_tr_b16 v[46:47], v15 offset:41472
    v_fma_f32 v75, v75, v68, v69
    v_fma_f32 v76, v76, v68, v69
    v_fma_f32 v77, v77, v68, v69
    v_cvt_pk_bf16_f32 v108, v70, v74
    v_cvt_pk_bf16_f32 v109, v71, v75
    v_cvt_pk_bf16_f32 v110, v72, v76
    v_cvt_pk_bf16_f32 v111, v73, v77
    ds_write_b64 v8, v[104:105] offset:0
    ds_write_b64 v8, v[106:107] offset:16
    ds_write_b64 v8, v[108:109] offset:32
    ds_write_b64 v8, v[110:111] offset:48
    v_subrev_u32 v9, 131072, v129
    s_mov_b64 exec, 0xffff
    ds_write2_b32 v7, v20, v21 offset0:0 offset1:16
    s_mov_b64 exec, -1
    s_waitcnt lgkmcnt(0)
    s_waitcnt vmcnt(5)
    s_barrier
    v_mfma_f32_32x32x16_bf16 v[80:95], v[32:35], v[144:147], 0
    v_mfma_f32_16x16x32_bf16 v[20:23], v[16:19], v[32:35], 0
    ds_read_b64_tr_b16 v[32:33], v12 offset:49152
    ds_read_b64_tr_b16 v[34:35], v12 offset:49664
    ds_read_b128 v[104:107], v9 offset:0
    ds_read_b128 v[108:111], v9 offset:1152
    ds_read2st64_b32 v[120:121], v31 offset0:0 offset1:1
    ds_read2st64_b32 v[122:123], v31 offset0:2 offset1:3
    v_mfma_f32_32x32x16_bf16 v[80:95], v[36:39], v[148:151], v[80:95]
    ds_read_b64_tr_b16 v[36:37], v13 offset:49152
    ds_read_b64_tr_b16 v[38:39], v13 offset:49664
    s_add_u32 m0, s53, 24576
    s_add_u32 s56, s50, 1376256
    buffer_load_dwordx4 v4, s[8:11], s56 offen lds
    s_lshl_b32 s58, s42, 4
    s_add_u32 s58, s58, s47
    s_mul_i32 s58, s58, 128
    s_mul_i32 s57, s46, 262144
    s_add_u32 s58, s58, s57
    s_add_u32 s58, s58, 4194304
    v_mfma_f32_32x32x16_bf16 v[80:95], v[40:43], v[152:155], v[80:95]
    ds_read_b64_tr_b16 v[40:41], v14 offset:49152
    ds_read_b64_tr_b16 v[42:43], v14 offset:49664
    s_waitcnt lgkmcnt(7)
    buffer_store_dwordx4 v[104:107], v130, s[16:19], s58 offen sc1
    s_waitcnt lgkmcnt(6)
    s_add_u32 s58, s58, 1024
    buffer_store_dwordx4 v[108:111], v130, s[16:19], s58 offen sc1
    s_waitcnt lgkmcnt(4)
    v_add_f32 v120, v120, v121
    v_add_f32 v122, v122, v123
    v_add_f32 v120, v120, v122
    v_cvt_pk_bf16_f32 v136, v120, v120
    v_lshlrev_b32 v137, 16, v136
    v_sub_f32 v137, v120, v137
    v_cvt_pk_bf16_f32 v137, v137, v137
    v_mfma_f32_32x32x16_bf16 v[80:95], v[44:47], v[156:159], v[80:95]
    ds_read_b64_tr_b16 v[44:45], v15 offset:49152
    ds_read_b64_tr_b16 v[46:47], v15 offset:49664
    v_mfma_f32_32x32x16_bf16 v[48:63], v[136:139], v[132:135], v[48:63]
    v_mfma_f32_32x32x16_bf16 v[80:95], v[32:35], v[160:163], v[80:95]
    v_mfma_f32_16x16x32_bf16 v[20:23], v[16:19], v[32:35], v[20:23]
    ds_read_b64_tr_b16 v[32:33], v12 offset:57344
    ds_read_b64_tr_b16 v[34:35], v12 offset:57856
    s_waitcnt lgkmcnt(6)
    v_mfma_f32_32x32x16_bf16 v[80:95], v[36:39], v[164:167], v[80:95]
    ds_read_b64_tr_b16 v[36:37], v13 offset:57344
    ds_read_b64_tr_b16 v[38:39], v13 offset:57856
    s_nop 3
    v_mul_f32 v48, v48, v30
    v_mul_f32 v49, v49, v30
    v_mul_f32 v50, v50, v30
    s_waitcnt lgkmcnt(6)
    v_mfma_f32_32x32x16_bf16 v[80:95], v[40:43], v[168:171], v[80:95]
    ds_read_b64_tr_b16 v[40:41], v14 offset:57344
    ds_read_b64_tr_b16 v[42:43], v14 offset:57856
    v_mul_f32 v51, v51, v30
    v_cvt_pk_bf16_f32 v120, v48, v49
    v_cvt_pk_bf16_f32 v121, v50, v51
    s_waitcnt lgkmcnt(6)
    v_mfma_f32_32x32x16_bf16 v[80:95], v[44:47], v[172:175], v[80:95]
    ds_read_b64_tr_b16 v[44:45], v15 offset:57344
    ds_read_b64_tr_b16 v[46:47], v15 offset:57856
    v_mul_f32 v52, v52, v30
    v_mul_f32 v53, v53, v30
    v_mul_f32 v54, v54, v30
    v_mul_f32 v55, v55, v30
    s_waitcnt vmcnt(4)
    s_barrier
    s_waitcnt lgkmcnt(6)
    v_mfma_f32_32x32x16_bf16 v[80:95], v[32:35], v[176:179], v[80:95]
    v_mfma_f32_16x16x32_bf16 v[20:23], v[16:19], v[32:35], v[20:23]
    ds_read_b64_tr_b16 v[32:33], v12 offset:0
    ds_read_b64_tr_b16 v[34:35], v12 offset:512
    v_cvt_pk_bf16_f32 v122, v52, v53
    v_cvt_pk_bf16_f32 v123, v54, v55
    v_mul_f32 v56, v56, v30
    s_waitcnt lgkmcnt(6)
    v_mfma_f32_32x32x16_bf16 v[80:95], v[36:39], v[180:183], v[80:95]
    ds_read_b64_tr_b16 v[36:37], v13 offset:0
    ds_read_b64_tr_b16 v[38:39], v13 offset:512
    v_mul_f32 v57, v57, v30
    v_mul_f32 v58, v58, v30
    v_mul_f32 v59, v59, v30
    v_cvt_pk_bf16_f32 v124, v56, v57
    s_add_u32 m0, s52, 0
    s_add_u32 s55, s48, 0
    buffer_load_dwordx4 v2, s[20:23], s55 offen offset:0 lds
    buffer_load_dwordx4 v3, s[20:23], s55 offen offset:1024 lds
    s_waitcnt lgkmcnt(6)
    v_mfma_f32_32x32x16_bf16 v[80:95], v[40:43], v[184:187], v[80:95]
    ds_read_b64_tr_b16 v[40:41], v14 offset:0
    ds_read_b64_tr_b16 v[42:43], v14 offset:512
    v_cvt_pk_bf16_f32 v125, v58, v59
    v_mul_f32 v60, v60, v30
    v_mul_f32 v61, v61, v30
    s_waitcnt lgkmcnt(6)
    v_mfma_f32_32x32x16_bf16 v[80:95], v[44:47], v[188:191], v[80:95]
    ds_read_b64_tr_b16 v[44:45], v15 offset:0
    ds_read_b64_tr_b16 v[46:47], v15 offset:512
    v_mul_f32 v62, v62, v30
    v_mul_f32 v63, v63, v30
    v_cvt_pk_bf16_f32 v126, v60, v61
    v_cvt_pk_bf16_f32 v127, v62, v63
    s_waitcnt lgkmcnt(6)
    v_mfma_f32_32x32x16_bf16 v[80:95], v[32:35], v[192:195], v[80:95]
    v_mfma_f32_16x16x32_bf16 v[20:23], v[16:19], v[32:35], v[20:23]
    ds_read_b64_tr_b16 v[32:33], v12 offset:8192
    ds_read_b64_tr_b16 v[34:35], v12 offset:8704
    ds_write_b64 v128, v[120:121] offset:0
    ds_write_b64 v128, v[122:123] offset:16
    ds_write_b64 v128, v[124:125] offset:32
    ds_write_b64 v128, v[126:127] offset:48
    s_waitcnt lgkmcnt(10)
    v_mfma_f32_32x32x16_bf16 v[80:95], v[36:39], v[196:199], v[80:95]
    ds_read_b64_tr_b16 v[36:37], v13 offset:8192
    ds_read_b64_tr_b16 v[38:39], v13 offset:8704
    s_add_u32 m0, s52, 16384
    s_add_u32 s55, s48, 128
    buffer_load_dwordx4 v2, s[20:23], s55 offen offset:0 lds
    buffer_load_dwordx4 v3, s[20:23], s55 offen offset:1024 lds
    s_waitcnt lgkmcnt(10)
    v_mfma_f32_32x32x16_bf16 v[80:95], v[40:43], v[200:203], v[80:95]
    ds_read_b64_tr_b16 v[40:41], v14 offset:8192
    ds_read_b64_tr_b16 v[42:43], v14 offset:8704
    s_waitcnt lgkmcnt(10)
    v_mfma_f32_32x32x16_bf16 v[80:95], v[44:47], v[204:207], v[80:95]
    ds_read_b64_tr_b16 v[44:45], v15 offset:8192
    ds_read_b64_tr_b16 v[46:47], v15 offset:8704
    s_waitcnt lgkmcnt(6)
    s_waitcnt vmcnt(4)
    s_barrier
    s_cmp_lg_u32 s42, 1
    s_cbranch_scc1 fs_f_11
    s_lshl_b32 s62, s46, 7
    s_lshl_b32 s63, s45, 2
    s_add_u32 s62, s62, s63
    s_add_u32 s62, s62, 22028288
    v_mov_b32 v142, 0
    v_mov_b32 v143, s59
    s_mov_b64 exec, 1
    buffer_store_dword v143, v142, s[16:19], s62 offen sc1
    s_mov_b64 exec, -1
fs_f_11:
    v_mfma_f32_32x32x16_bf16 v[80:95], v[32:35], v[208:211], v[80:95]
    v_mfma_f32_16x16x32_bf16 v[20:23], v[16:19], v[32:35], v[20:23]
    ds_read_b64_tr_b16 v[32:33], v12 offset:16384
    ds_read_b64_tr_b16 v[34:35], v12 offset:16896
    ds_read_b128 v[120:123], v129 offset:0
    ds_read_b128 v[124:127], v129 offset:1152
    s_waitcnt lgkmcnt(8)
    v_mfma_f32_32x32x16_bf16 v[80:95], v[36:39], v[212:215], v[80:95]
    ds_read_b64_tr_b16 v[36:37], v13 offset:16384
    ds_read_b64_tr_b16 v[38:39], v13 offset:16896
    s_waitcnt lgkmcnt(8)
    v_mfma_f32_32x32x16_bf16 v[80:95], v[40:43], v[216:219], v[80:95]
    ds_read_b64_tr_b16 v[40:41], v14 offset:16384
    ds_read_b64_tr_b16 v[42:43], v14 offset:16896
    s_lshl_b32 s55, s42, 4
    s_add_u32 s55, s55, s47
    s_mul_i32 s55, s55, 2688
    s_mul_i32 s57, s46, 192
    s_add_u32 s55, s55, s57
    s_add_u32 s55, s55, 8388608
    s_waitcnt lgkmcnt(5)
    buffer_store_dwordx4 v[120:123], v131, s[16:19], s55 offen sc1
    s_waitcnt lgkmcnt(4)
    s_add_u32 s55, s55, 21504
    buffer_store_dwordx4 v[124:127], v131, s[16:19], s55 offen sc1
    v_mfma_f32_32x32x16_bf16 v[80:95], v[44:47], v[220:223], v[80:95]
    ds_read_b64_tr_b16 v[44:45], v15 offset:16384
    ds_read_b64_tr_b16 v[46:47], v15 offset:16896
    v_mfma_f32_32x32x16_bf16 v[80:95], v[32:35], v[224:227], v[80:95]
    v_mfma_f32_16x16x32_bf16 v[20:23], v[16:19], v[32:35], v[20:23]
    ds_read_b64_tr_b16 v[32:33], v12 offset:24576
    ds_read_b64_tr_b16 v[34:35], v12 offset:25088
    s_waitcnt lgkmcnt(6)
    v_mfma_f32_32x32x16_bf16 v[80:95], v[36:39], v[228:231], v[80:95]
    ds_read_b64_tr_b16 v[36:37], v13 offset:24576
    ds_read_b64_tr_b16 v[38:39], v13 offset:25088
    s_waitcnt lgkmcnt(6)
    v_mfma_f32_32x32x16_bf16 v[80:95], v[40:43], v[232:235], v[80:95]
    ds_read_b64_tr_b16 v[40:41], v14 offset:24576
    ds_read_b64_tr_b16 v[42:43], v14 offset:25088
    s_waitcnt lgkmcnt(6)
    v_mfma_f32_32x32x16_bf16 v[80:95], v[44:47], v[236:239], v[80:95]
    ds_read_b64_tr_b16 v[44:45], v15 offset:24576
    ds_read_b64_tr_b16 v[46:47], v15 offset:25088
    v_lshlrev_b32 v141, 2, v1
    s_cmp_lg_u32 s42, 0
    s_cbranch_scc1 pi_f_12
    s_lshl_b32 s50, s46, 7
    s_add_u32 s50, s50, 22028288
    s_mov_b32 exec_lo, 65535
    s_mov_b32 exec_hi, 0
    buffer_load_dword v70, v141, s[16:19], s50 offen sc1
    s_mov_b64 exec, -1
pi_f_12:
    s_barrier
    s_waitcnt lgkmcnt(6)
    v_mfma_f32_32x32x16_bf16 v[80:95], v[32:35], v[240:243], v[80:95]
    v_mfma_f32_16x16x32_bf16 v[20:23], v[16:19], v[32:35], v[20:23]
    s_waitcnt lgkmcnt(4)
    v_mfma_f32_32x32x16_bf16 v[80:95], v[36:39], v[244:247], v[80:95]
    s_waitcnt lgkmcnt(2)
    v_mfma_f32_32x32x16_bf16 v[80:95], v[40:43], v[248:251], v[80:95]
    s_waitcnt lgkmcnt(0)
    v_mfma_f32_32x32x16_bf16 v[80:95], v[44:47], v[252:255], v[80:95]
    s_mov_b64 exec, 0xffff
    s_nop 0
    ds_write2_b32 v7, v20, v21 offset0:0 offset1:16
    s_mov_b64 exec, -1
    s_waitcnt lgkmcnt(0)
    s_barrier
L_k2:
    v_lshrrev_b32 v104, 3, v1
    v_lshrrev_b32 v105, 4, v1
    v_and_b32 v106, 7, v1
    v_lshlrev_b32 v2, 12, v104
    v_xor_b32 v107, v106, v105
    v_lshlrev_b32 v107, 4, v107
    v_add_u32 v3, 31744, v2
    v_add_u32 v2, v2, v107
    v_xor_b32 v107, 64, v107
    v_add_u32 v3, v3, v107
    v_and_b32 v107, 1, v105
    v_lshlrev_b32 v107, 2, v107
    v_xor_b32 v107, v106, v107
    v_lshlrev_b32 v107, 4, v107
    v_mul_u32_u24 v4, 128, v104
    v_add_u32 v4, v4, v107
    s_lshl_b32 s55, s42, 4
    s_add_u32 s55, s55, s47
    s_lshl_b32 s48, s55, 12
    s_mul_i32 s55, s42, 1024
    s_lshl_b32 s56, s46, 18
    s_add_u32 s49, s55, s56
    s_add_u32 s49, s49, 4194304
    s_lshl_b32 s52, s42, 11
    s_add_u32 s52, s52, 0
    s_lshl_b32 s53, s42, 10
    s_add_u32 s53, s53, 98304
    s_mov_b32 s22, 8388608
    s_mov_b32 s23, 0x20000
    s_mov_b32 s38, 4096
    s_mov_b32 s39, 0x20000
    s_mov_b32 s26, 802816
    s_mov_b32 s27, 0x20000
    s_mov_b32 s30, 401408
    s_mov_b32 s31, 0x20000
    s_mov_b32 s34, 1835008
    s_mov_b32 s35, 0x20000
    s_add_u32 m0, s52, 65536
    s_add_u32 s55, s48, 512
    buffer_load_dwordx4 v2, s[20:23], s55 offen offset:0 lds
    buffer_load_dwordx4 v3, s[20:23], s55 offen offset:1024 lds
    s_cmp_lg_u32 s42, 0
    s_cbranch_scc1 pc_f_13_ok
    s_waitcnt vmcnt(2)
    s_mov_b32 exec_lo, 65535
    s_mov_b32 exec_hi, 0
    v_cmp_ne_u32 vcc, s59, v70
    s_mov_b64 exec, -1
    s_cmp_eq_u64 vcc, 0
    s_cbranch_scc1 pc_f_13_ok
    s_mov_b32 exec_lo, 65535
    s_mov_b32 exec_hi, 0
    buffer_load_dword v200, v141, s[16:19], s50 offen sc1
    s_mov_b64 exec, -1
    s_sleep 2
    s_mov_b32 exec_lo, 65535
    s_mov_b32 exec_hi, 0
    buffer_load_dword v201, v141, s[16:19], s50 offen sc1
    s_mov_b64 exec, -1
    s_sleep 2
    s_mov_b32 exec_lo, 65535
    s_mov_b32 exec_hi, 0
    buffer_load_dword v202, v141, s[16:19], s50 offen sc1
    s_mov_b64 exec, -1
    s_sleep 2
    s_mov_b32 s51, 0
pc_f_13_chk:
    s_mov_b32 exec_lo, 65535
    s_mov_b32 exec_hi, 0
    buffer_load_dword v70, v141, s[16:19], s50 offen sc1
    s_mov_b64 exec, -1
    s_waitcnt vmcnt(3)
    s_mov_b32 exec_lo, 65535
    s_mov_b32 exec_hi, 0
    v_cmp_ne_u32 vcc, s59, v200
    s_mov_b64 exec, -1
    s_cmp_eq_u64 vcc, 0
    s_cbranch_scc1 pc_f_13_ok
    s_mov_b32 exec_lo, 65535
    s_mov_b32 exec_hi, 0
    buffer_load_dword v200, v141, s[16:19], s50 offen sc1
    s_mov_b64 exec, -1
    s_waitcnt vmcnt(3)
    s_mov_b32 exec_lo, 65535
    s_mov_b32 exec_hi, 0
    v_cmp_ne_u32 vcc, s59, v201
    s_mov_b64 exec, -1
    s_cmp_eq_u64 vcc, 0
    s_cbranch_scc1 pc_f_13_ok
    s_mov_b32 exec_lo, 65535
    s_mov_b32 exec_hi, 0
    buffer_load_dword v201, v141, s[16:19], s50 offen sc1
    s_mov_b64 exec, -1
    s_waitcnt vmcnt(3)
    s_mov_b32 exec_lo, 65535
    s_mov_b32 exec_hi, 0
    v_cmp_ne_u32 vcc, s59, v202
    s_mov_b64 exec, -1
    s_cmp_eq_u64 vcc, 0
    s_cbranch_scc1 pc_f_13_ok
    s_mov_b32 exec_lo, 65535
    s_mov_b32 exec_hi, 0
    buffer_load_dword v202, v141, s[16:19], s50 offen sc1
    s_mov_b64 exec, -1
    s_waitcnt vmcnt(3)
    s_mov_b32 exec_lo, 65535
    s_mov_b32 exec_hi, 0
    v_cmp_ne_u32 vcc, s59, v70
    s_mov_b64 exec, -1
    s_cmp_eq_u64 vcc, 0
    s_cbranch_scc1 pc_f_13_ok
    s_add_u32 s51, s51, 1
    s_cmp_lt_u32 s51, 8192
    s_cbranch_scc1 pc_f_13_chk
pc_f_13_ok:
    s_barrier
    s_add_u32 m0, s53, 0
    s_add_u32 s56, s49, 0
    buffer_load_dwordx4 v4, s[16:19], s56 offen lds
    s_barrier
    s_add_u32 m0, s53, 8192
    s_add_u32 s56, s49, 8192
    buffer_load_dwordx4 v4, s[16:19], s56 offen lds
    s_barrier
    s_add_u32 m0, s53, 16384
    s_add_u32 s56, s49, 16384
    buffer_load_dwordx4 v4, s[16:19], s56 offen lds
    s_add_u32 m0, s53, 24576
    s_add_u32 s56, s49, 24576
    buffer_load_dwordx4 v4, s[16:19], s56 offen lds
    s_add_u32 m0, s53, 32768
    s_add_u32 s56, s49, 32768
    buffer_load_dwordx4 v4, s[16:19], s56 offen lds
    v_lshlrev_b32 v104, 5, v0
    v_and_b32 v105, 31, v1
    v_lshlrev_b32 v105, 1, v105
    s_lshl_b32 s58, s43, 5
    s_add_u32 s58, s58, s47
    s_lshl_b32 s58, s58, 1
    v_and_b32 v108, 31, v1
    v_lshrrev_b32 v109, 5, v1
    v_and_b32 v110, 15, v1
    v_and_b32 v111, 3, v110
    v_lshlrev_b32 v111, 3, v111
    v_lshrrev_b32 v110, 2, v110
    v_lshrrev_b32 v112, 4, v1
    v_and_b32 v112, 1, v112
    v_lshlrev_b32 v112, 5, v112
    v_add_u32 v112, v112, v111
    s_lshl_b32 s55, s44, 1
    s_add_u32 s55, s55, s43
    v_lshlrev_b32 v113, 3, v109
    v_add_u32 v113, v113, v110
    v_lshlrev_b32 v113, 7, v113
    v_add_u32 v113, v113, v112
    v_lshrrev_b32 v110, 1, v110
    v_xor_b32 v110, s44, v110
    v_lshlrev_b32 v110, 6, v110
    v_add_u32 v113, v113, v110
    v_lshrrev_b32 v111, 1, v108
    v_and_b32 v111, 7, v111
    v_lshlrev_b32 v112, 7, v108
    s_lshl_b32 s56, s43, 12
    s_add_u32 s56, s56, 0
    v_add_u32 v112, s56, v112
    s_add_u32 s56, s55, 0
    s_and_b32 s56, s56, 3
    s_lshl_b32 s57, s56, 1
    v_add_u32 v110, s57, v109
    v_xor_b32 v110, v110, v111
    v_lshlrev_b32 v110, 4, v110
    v_add_u32 v8, v112, v110
    s_lshl_b32 s57, s56, 11
    s_add_u32 s57, s57, 98304
    v_add_u32 v16, s57, v113
    v_add_u32 v12, 0x10000, v8
    s_add_u32 s56, s55, 1
    s_and_b32 s56, s56, 3
    s_lshl_b32 s57, s56, 1
    v_add_u32 v110, s57, v109
    v_xor_b32 v110, v110, v111
    v_lshlrev_b32 v110, 4, v110
    v_add_u32 v9, v112, v110
    s_lshl_b32 s57, s56, 11
    s_add_u32 s57, s57, 98304
    v_add_u32 v17, s57, v113
    v_add_u32 v13, 0x10000, v9
    s_add_u32 s56, s55, 2
    s_and_b32 s56, s56, 3
    s_lshl_b32 s57, s56, 1
    v_add_u32 v110, s57, v109
    v_xor_b32 v110, v110, v111
    v_lshlrev_b32 v110, 4, v110
    v_add_u32 v10, v112, v110
    s_lshl_b32 s57, s56, 11
    s_add_u32 s57, s57, 98304
    v_add_u32 v18, s57, v113
    v_add_u32 v14, 0x10000, v10
    s_add_u32 s56, s55, 3
    s_and_b32 s56, s56, 3
    s_lshl_b32 s57, s56, 1
    v_add_u32 v110, s57, v109
    v_xor_b32 v110, v110, v111
    v_lshlrev_b32 v110, 4, v110
    v_add_u32 v11, v112, v110
    s_lshl_b32 s57, s56, 11
    s_add_u32 s57, s57, 98304
    v_add_u32 v19, s57, v113
    v_add_u32 v15, 0x10000, v11
    buffer_load_ushort v20, v105, s[36:39], s58 offen
    ds_read2st64_b32 v[120:121], v31 offset0:0 offset1:1
    ds_read2st64_b32 v[122:123], v31 offset0:2 offset1:3
    s_waitcnt lgkmcnt(0)
    v_add_f32 v120, v120, v121
    v_add_f32 v122, v122, v123
    v_add_f32 v120, v120, v122
    v_cvt_pk_bf16_f32 v136, v120, v120
    v_lshlrev_b32 v137, 16, v136
    v_sub_f32 v137, v120, v137
    v_cvt_pk_bf16_f32 v137, v137, v137
    s_nop 1
    v_mfma_f32_32x32x16_bf16 v[80:95], v[136:139], v[132:135], v[80:95]
    s_nop 11
    v_mul_f32 v80, v80, v30
    v_mul_f32 v81, v81, v30
    v_mul_f32 v82, v82, v30
    v_mul_f32 v83, v83, v30
    v_cvt_pk_bf16_f32 v96, v80, v81
    v_cvt_pk_bf16_f32 v97, v82, v83
    v_mul_f32 v84, v84, v30
    v_mul_f32 v85, v85, v30
    v_mul_f32 v86, v86, v30
    v_mul_f32 v87, v87, v30
    v_cvt_pk_bf16_f32 v98, v84, v85
    v_cvt_pk_bf16_f32 v99, v86, v87
    v_mul_f32 v88, v88, v30
    v_mul_f32 v89, v89, v30
    v_mul_f32 v90, v90, v30
    v_mul_f32 v91, v91, v30
    v_cvt_pk_bf16_f32 v100, v88, v89
    v_cvt_pk_bf16_f32 v101, v90, v91
    v_mul_f32 v92, v92, v30
    v_mul_f32 v93, v93, v30
    v_mul_f32 v94, v94, v30
    v_mul_f32 v95, v95, v30
    v_cvt_pk_bf16_f32 v102, v92, v93
    v_cvt_pk_bf16_f32 v103, v94, v95
    s_waitcnt vmcnt(8)
    s_barrier
    s_cmp_lg_u32 s42, 2
    s_cbranch_scc1 fs_f_14
    s_lshl_b32 s62, s45, 7
    s_lshl_b32 s63, s46, 2
    s_add_u32 s62, s62, s63
    s_add_u32 s62, s62, 22032384
    v_mov_b32 v162, 0
    v_mov_b32 v163, s59
    s_mov_b64 exec, 1
    buffer_store_dword v163, v162, s[16:19], s62 offen sc1
    s_mov_b64 exec, -1
fs_f_14:
    s_waitcnt vmcnt(5)
    s_waitcnt lgkmcnt(0)
    s_barrier
    ds_read_b128 v[32:35], v8 offset:0
    ds_read_b64_tr_b16 v[48:49], v16 offset:0
    ds_read_b64_tr_b16 v[50:51], v16 offset:512
    ds_read_b128 v[36:39], v9 offset:0
    ds_read_b64_tr_b16 v[52:53], v17 offset:0
    ds_read_b64_tr_b16 v[54:55], v17 offset:512
    ds_read_b128 v[40:43], v10 offset:0
    ds_read_b64_tr_b16 v[56:57], v18 offset:0
    ds_read_b64_tr_b16 v[58:59], v18 offset:512
    ds_read_b128 v[44:47], v11 offset:0
    ds_read_b64_tr_b16 v[60:61], v19 offset:0
    ds_read_b64_tr_b16 v[62:63], v19 offset:512
    s_waitcnt vmcnt(4)
    s_barrier
    s_waitcnt lgkmcnt(9)
    v_mfma_f32_32x32x16_bf16 v[64:79], v[48:51], v[32:35], 0
    ds_read_b128 v[32:35], v8 offset:16384
    ds_read_b64_tr_b16 v[48:49], v16 offset:8192
    ds_read_b64_tr_b16 v[50:51], v16 offset:8704
    s_add_u32 m0, s52, 81920
    s_add_u32 s55, s48, 640
    buffer_load_dwordx4 v2, s[20:23], s55 offen offset:0 lds
    buffer_load_dwordx4 v3, s[20:23], s55 offen offset:1024 lds
    s_add_u32 m0, s53, 40960
    s_add_u32 s56, s49, 40960
    buffer_load_dwordx4 v4, s[16:19], s56 offen lds
    v_mov_b32 v24, 0xc0135761
    v_mov_b32 v25, 0xbdd2d3e8
    s_waitcnt lgkmcnt(9)
    v_mfma_f32_32x32x16_bf16 v[64:79], v[52:55], v[36:39], v[64:79]
    ds_read_b128 v[36:39], v9 offset:16384
    ds_read_b64_tr_b16 v[52:53], v17 offset:8192
    ds_read_b64_tr_b16 v[54:55], v17 offset:8704
    v_and_b32 v26, 31, v1
    v_lshrrev_b32 v27, 5, v1
    s_lshl_b32 s57, s43, 5
    s_waitcnt lgkmcnt(9)
    v_mfma_f32_32x32x16_bf16 v[64:79], v[56:59], v[40:43], v[64:79]
    ds_read_b128 v[40:43], v10 offset:16384
    ds_read_b64_tr_b16 v[56:57], v18 offset:8192
    ds_read_b64_tr_b16 v[58:59], v18 offset:8704
    v_add_u32 v28, s57, v26
    v_lshlrev_b32 v28, 7, v28
    s_waitcnt lgkmcnt(9)
    v_mfma_f32_32x32x16_bf16 v[64:79], v[60:63], v[44:47], v[64:79]
    ds_read_b128 v[44:47], v11 offset:16384
    ds_read_b64_tr_b16 v[60:61], v19 offset:8192
    ds_read_b64_tr_b16 v[62:63], v19 offset:8704
    v_lshlrev_b32 v27, 3, v27
    v_add_u32 v28, v28, v27
    v_add_u32 v28, 32768, v28
    s_waitcnt vmcnt(6)
    s_barrier
    s_waitcnt lgkmcnt(9)
    v_mfma_f32_32x32x16_bf16 v[64:79], v[48:51], v[32:35], v[64:79]
    ds_read_b128 v[32:35], v8 offset:32768
    ds_read_b64_tr_b16 v[48:49], v16 offset:16384
    ds_read_b64_tr_b16 v[50:51], v16 offset:16896
    s_add_u32 m0, s52, 0
    s_add_u32 s55, s48, 768
    buffer_load_dwordx4 v2, s[20:23], s55 offen offset:0 lds
    buffer_load_dwordx4 v3, s[20:23], s55 offen offset:1024 lds
    s_add_u32 m0, s53, 0
    s_add_u32 s56, s49, 49152
    buffer_load_dwordx4 v4, s[16:19], s56 offen lds
    v_lshrrev_b32 v26, 1, v26
    v_and_b32 v26, 7, v26
    s_waitcnt lgkmcnt(9)
    v_mfma_f32_32x32x16_bf16 v[64:79], v[52:55], v[36:39], v[64:79]
    ds_read_b128 v[36:39], v9 offset:32768
    ds_read_b64_tr_b16 v[52:53], v17 offset:16384
    ds_read_b64_tr_b16 v[54:55], v17 offset:16896
    s_lshl_b32 s57, s44, 2
    v_xor_b32 v26, s57, v26
    v_lshl_add_u32 v21, v26, 4, v28
    s_waitcnt lgkmcnt(9)
    v_mfma_f32_32x32x16_bf16 v[64:79], v[56:59], v[40:43], v[64:79]
    ds_read_b128 v[40:43], v10 offset:32768
    ds_read_b64_tr_b16 v[56:57], v18 offset:16384
    ds_read_b64_tr_b16 v[58:59], v18 offset:16896
    v_lshrrev_b32 v26, 3, v1
    v_and_b32 v27, 7, v1
    v_lshlrev_b32 v28, 4, v27
    s_waitcnt lgkmcnt(9)
    v_mfma_f32_32x32x16_bf16 v[64:79], v[60:63], v[44:47], v[64:79]
    ds_read_b128 v[44:47], v11 offset:32768
    ds_read_b64_tr_b16 v[60:61], v19 offset:16384
    ds_read_b64_tr_b16 v[62:63], v19 offset:16896
    v_mul_u32_u24 v23, 128, v26
    v_add_u32 v23, v23, v28
    s_waitcnt vmcnt(8)
    s_barrier
    s_waitcnt lgkmcnt(9)
    v_mfma_f32_32x32x16_bf16 v[64:79], v[48:51], v[32:35], v[64:79]
    ds_read_b128 v[32:35], v8 offset:49152
    ds_read_b64_tr_b16 v[48:49], v16 offset:24576
    ds_read_b64_tr_b16 v[50:51], v16 offset:25088
    s_add_u32 m0, s52, 16384
    s_add_u32 s55, s48, 896
    buffer_load_dwordx4 v2, s[20:23], s55 offen offset:0 lds
    buffer_load_dwordx4 v3, s[20:23], s55 offen offset:1024 lds
    s_add_u32 m0, s53, 8192
    s_add_u32 s56, s49, 57344
    buffer_load_dwordx4 v4, s[16:19], s56 offen lds
    s_lshl_b32 s57, s42, 4
    v_add_u32 v26, s57, v26
    v_lshrrev_b32 v28, 4, v1
    s_waitcnt lgkmcnt(9)
    v_mfma_f32_32x32x16_bf16 v[64:79], v[52:55], v[36:39], v[64:79]
    ds_read_b128 v[36:39], v9 offset:49152
    ds_read_b64_tr_b16 v[52:53], v17 offset:24576
    ds_read_b64_tr_b16 v[54:55], v17 offset:25088
    v_xor_b32 v27, v27, v28
    v_lshlrev_b32 v27, 4, v27
    s_waitcnt lgkmcnt(9)
    v_mfma_f32_32x32x16_bf16 v[64:79], v[56:59], v[40:43], v[64:79]
    ds_read_b128 v[40:43], v10 offset:49152
    ds_read_b64_tr_b16 v[56:57], v18 offset:24576
    ds_read_b64_tr_b16 v[58:59], v18 offset:25088
    v_lshl_add_u32 v22, v26, 7, v27
    v_add_u32 v22, 32768, v22
    v_xor_b32 v29, 64, v22
    s_waitcnt lgkmcnt(9)
    v_mfma_f32_32x32x16_bf16 v[64:79], v[60:63], v[44:47], v[64:79]
    ds_read_b128 v[44:47], v11 offset:49152
    ds_read_b64_tr_b16 v[60:61], v19 offset:24576
    ds_read_b64_tr_b16 v[62:63], v19 offset:25088
    v_xor_b32 v26, 16, v21
    v_xor_b32 v27, 32, v21
    v_xor_b32 v28, 48, v21
    s_waitcnt vmcnt(10)
    s_barrier
    s_waitcnt lgkmcnt(9)
    v_mfma_f32_32x32x16_bf16 v[64:79], v[48:51], v[32:35], v[64:79]
    ds_read_b128 v[32:35], v12 offset:0
    ds_read_b64_tr_b16 v[48:49], v16 offset:32768
    ds_read_b64_tr_b16 v[50:51], v16 offset:33280
    s_add_u32 m0, s52, 32768
    s_add_u32 s55, s48, 1024
    buffer_load_dwordx4 v2, s[20:23], s55 offen offset:0 lds
    buffer_load_dwordx4 v3, s[20:23], s55 offen offset:1024 lds
    s_add_u32 m0, s53, 16384
    s_add_u32 s56, s49, 65536
    buffer_load_dwordx4 v4, s[16:19], s56 offen lds
    s_waitcnt lgkmcnt(9)
    v_mfma_f32_32x32x16_bf16 v[64:79], v[52:55], v[36:39], v[64:79]
    ds_read_b128 v[36:39], v13 offset:0
    ds_read_b64_tr_b16 v[52:53], v17 offset:32768
    ds_read_b64_tr_b16 v[54:55], v17 offset:33280
    s_waitcnt lgkmcnt(9)
    v_mfma_f32_32x32x16_bf16 v[64:79], v[56:59], v[40:43], v[64:79]
    ds_read_b128 v[40:43], v14 offset:0
    ds_read_b64_tr_b16 v[56:57], v18 offset:32768
    ds_read_b64_tr_b16 v[58:59], v18 offset:33280
    s_waitcnt lgkmcnt(9)
    v_mfma_f32_32x32x16_bf16 v[64:79], v[60:63], v[44:47], v[64:79]
    ds_read_b128 v[44:47], v15 offset:0
    ds_read_b64_tr_b16 v[60:61], v19 offset:32768
    ds_read_b64_tr_b16 v[62:63], v19 offset:33280
    s_waitcnt vmcnt(9)
    s_barrier
    s_waitcnt lgkmcnt(9)
    v_mfma_f32_32x32x16_bf16 v[64:79], v[48:51], v[32:35], v[64:79]
    ds_read_b128 v[32:35], v12 offset:16384
    ds_read_b64_tr_b16 v[48:49], v16 offset:40960
    ds_read_b64_tr_b16 v[50:51], v16 offset:41472
    s_add_u32 m0, s52, 49152
    s_add_u32 s55, s48, 1152
    buffer_load_dwordx4 v2, s[20:23], s55 offen offset:0 lds
    buffer_load_dwordx4 v3, s[20:23], s55 offen offset:1024 lds
    s_add_u32 m0, s53, 24576
    s_add_u32 s56, s49, 73728
    buffer_load_dwordx4 v4, s[16:19], s56 offen lds
    v_lshlrev_b32 v80, 16, v96
    v_and_b32 v81, 0xffff0000, v96
    s_waitcnt lgkmcnt(9)
    v_mfma_f32_32x32x16_bf16 v[64:79], v[52:55], v[36:39], v[64:79]
    ds_read_b128 v[36:39], v13 offset:16384
    ds_read_b64_tr_b16 v[52:53], v17 offset:40960
    ds_read_b64_tr_b16 v[54:55], v17 offset:41472
    v_lshlrev_b32 v82, 16, v97
    v_and_b32 v83, 0xffff0000, v97
    s_waitcnt lgkmcnt(9)
    v_mfma_f32_32x32x16_bf16 v[64:79], v[56:59], v[40:43], v[64:79]
    ds_read_b128 v[40:43], v14 offset:16384
    ds_read_b64_tr_b16 v[56:57], v18 offset:40960
    ds_read_b64_tr_b16 v[58:59], v18 offset:41472
    v_mul_f32 v104, v80, v80
    v_mul_f32 v105, v81, v81
    s_waitcnt lgkmcnt(9)
    v_mfma_f32_32x32x16_bf16 v[64:79], v[60:63], v[44:47], v[64:79]
    ds_read_b128 v[44:47], v15 offset:16384
    ds_read_b64_tr_b16 v[60:61], v19 offset:40960
    ds_read_b64_tr_b16 v[62:63], v19 offset:41472
    v_mul_f32 v106, v82, v82
    v_mul_f32 v107, v83, v83
    v_fma_f32 v104, v104, v25, v24
    s_waitcnt vmcnt(9)
    s_barrier
    s_waitcnt lgkmcnt(9)
    v_mfma_f32_32x32x16_bf16 v[64:79], v[48:51], v[32:35], v[64:79]
    ds_read_b128 v[32:35], v8 offset:0
    ds_read_b64_tr_b16 v[48:49], v16 offset:0
    ds_read_b64_tr_b16 v[50:51], v16 offset:512
    s_add_u32 m0, s52, 65536
    s_add_u32 s55, s48, 1280
    buffer_load_dwordx4 v2, s[20:23], s55 offen offset:0 lds
    buffer_load_dwordx4 v3, s[20:23], s55 offen offset:1024 lds
    s_add_u32 m0, s53, 32768
    s_add_u32 s56, s49, 81920
    buffer_load_dwordx4 v4, s[16:19], s56 offen lds
    v_fma_f32 v105, v105, v25, v24
    v_fma_f32 v106, v106, v25, v24
    s_waitcnt lgkmcnt(9)
    v_mfma_f32_32x32x16_bf16 v[64:79], v[52:55], v[36:39], v[64:79]
    ds_read_b128 v[36:39], v9 offset:0
    ds_read_b64_tr_b16 v[52:53], v17 offset:0
    ds_read_b64_tr_b16 v[54:55], v17 offset:512
    v_fma_f32 v107, v107, v25, v24
    v_mul_f32 v104, v80, v104
    s_waitcnt lgkmcnt(9)
    v_mfma_f32_32x32x16_bf16 v[64:79], v[56:59], v[40:43], v[64:79]
    ds_read_b128 v[40:43], v10 offset:0
    ds_read_b64_tr_b16 v[56:57], v18 offset:0
    ds_read_b64_tr_b16 v[58:59], v18 offset:512
    v_mul_f32 v105, v81, v105
    v_mul_f32 v106, v82, v106
    v_mul_f32 v107, v83, v107
    s_waitcnt lgkmcnt(9)
    v_mfma_f32_32x32x16_bf16 v[64:79], v[60:63], v[44:47], v[64:79]
    ds_read_b128 v[44:47], v11 offset:0
    ds_read_b64_tr_b16 v[60:61], v19 offset:0
    ds_read_b64_tr_b16 v[62:63], v19 offset:512
    v_exp_f32 v104, v104
    v_exp_f32 v105, v105
    s_waitcnt vmcnt(9)
    s_barrier
    s_waitcnt lgkmcnt(9)
    v_mfma_f32_32x32x16_bf16 v[64:79], v[48:51], v[32:35], v[64:79]
    ds_read_b128 v[32:35], v8 offset:16384
    ds_read_b64_tr_b16 v[48:49], v16 offset:8192
    ds_read_b64_tr_b16 v[50:51], v16 offset:8704
    s_add_u32 m0, s52, 81920
    s_add_u32 s55, s48, 1408
    buffer_load_dwordx4 v2, s[20:23], s55 offen offset:0 lds
    buffer_load_dwordx4 v3, s[20:23], s55 offen offset:1024 lds
    s_add_u32 m0, s53, 40960
    s_add_u32 s56, s49, 90112
    buffer_load_dwordx4 v4, s[16:19], s56 offen lds
    v_exp_f32 v106, v106
    v_exp_f32 v107, v107
    s_waitcnt lgkmcnt(9)
    v_mfma_f32_32x32x16_bf16 v[64:79], v[52:55], v[36:39], v[64:79]
    ds_read_b128 v[36:39], v9 offset:16384
    ds_read_b64_tr_b16 v[52:53], v17 offset:8192
    ds_read_b64_tr_b16 v[54:55], v17 offset:8704
    v_add_f32 v104, 1.0, v104
    v_add_f32 v105, 1.0, v105
    v_add_f32 v106, 1.0, v106
    s_waitcnt lgkmcnt(9)
    v_mfma_f32_32x32x16_bf16 v[64:79], v[56:59], v[40:43], v[64:79]
    ds_read_b128 v[40:43], v10 offset:16384
    ds_read_b64_tr_b16 v[56:57], v18 offset:8192
    ds_read_b64_tr_b16 v[58:59], v18 offset:8704
    v_add_f32 v107, 1.0, v107
    v_rcp_f32 v104, v104
    s_waitcnt lgkmcnt(9)
    v_mfma_f32_32x32x16_bf16 v[64:79], v[60:63], v[44:47], v[64:79]
    ds_read_b128 v[44:47], v11 offset:16384
    ds_read_b64_tr_b16 v[60:61], v19 offset:8192
    ds_read_b64_tr_b16 v[62:63], v19 offset:8704
    v_rcp_f32 v105, v105
    v_rcp_f32 v106, v106
    s_waitcnt vmcnt(9)
    s_barrier
    s_waitcnt lgkmcnt(9)
    v_mfma_f32_32x32x16_bf16 v[64:79], v[48:51], v[32:35], v[64:79]
    ds_read_b128 v[32:35], v8 offset:32768
    ds_read_b64_tr_b16 v[48:49], v16 offset:16384
    ds_read_b64_tr_b16 v[50:51], v16 offset:16896
    s_add_u32 m0, s52, 0
    s_add_u32 s55, s48, 1536
    buffer_load_dwordx4 v2, s[20:23], s55 offen offset:0 lds
    buffer_load_dwordx4 v3, s[20:23], s55 offen offset:1024 lds
    s_add_u32 m0, s53, 0
    s_add_u32 s56, s49, 98304
    buffer_load_dwordx4 v4, s[16:19], s56 offen lds
    v_rcp_f32 v107, v107
    v_mul_f32 v80, v80, v104
    s_waitcnt lgkmcnt(9)
    v_mfma_f32_32x32x16_bf16 v[64:79], v[52:55], v[36:39], v[64:79]
    ds_read_b128 v[36:39], v9 offset:32768
    ds_read_b64_tr_b16 v[52:53], v17 offset:16384
    ds_read_b64_tr_b16 v[54:55], v17 offset:16896
    v_mul_f32 v81, v81, v105
    v_mul_f32 v82, v82, v106
    v_mul_f32 v83, v83, v107
    s_waitcnt lgkmcnt(9)
    v_mfma_f32_32x32x16_bf16 v[64:79], v[56:59], v[40:43], v[64:79]
    ds_read_b128 v[40:43], v10 offset:32768
    ds_read_b64_tr_b16 v[56:57], v18 offset:16384
    ds_read_b64_tr_b16 v[58:59], v18 offset:16896
    v_lshlrev_b32 v84, 16, v98
    v_and_b32 v85, 0xffff0000, v98
    s_waitcnt lgkmcnt(9)
    v_mfma_f32_32x32x16_bf16 v[64:79], v[60:63], v[44:47], v[64:79]
    ds_read_b128 v[44:47], v11 offset:32768
    ds_read_b64_tr_b16 v[60:61], v19 offset:16384
    ds_read_b64_tr_b16 v[62:63], v19 offset:16896
    v_lshlrev_b32 v86, 16, v99
    v_and_b32 v87, 0xffff0000, v99
    s_waitcnt vmcnt(9)
    s_barrier
    s_waitcnt lgkmcnt(9)
    v_mfma_f32_32x32x16_bf16 v[64:79], v[48:51], v[32:35], v[64:79]
    ds_read_b128 v[32:35], v8 offset:49152
    ds_read_b64_tr_b16 v[48:49], v16 offset:24576
    ds_read_b64_tr_b16 v[50:51], v16 offset:25088
    s_add_u32 m0, s52, 16384
    s_add_u32 s55, s48, 1664
    buffer_load_dwordx4 v2, s[20:23], s55 offen offset:0 lds
    buffer_load_dwordx4 v3, s[20:23], s55 offen offset:1024 lds
    s_add_u32 m0, s53, 8192
    s_add_u32 s56, s49, 106496
    buffer_load_dwordx4 v4, s[16:19], s56 offen lds
    v_mul_f32 v108, v84, v84
    v_mul_f32 v109, v85, v85
    v_mul_f32 v110, v86, v86
    s_waitcnt lgkmcnt(9)
    v_mfma_f32_32x32x16_bf16 v[64:79], v[52:55], v[36:39], v[64:79]
    ds_read_b128 v[36:39], v9 offset:49152
    ds_read_b64_tr_b16 v[52:53], v17 offset:24576
    ds_read_b64_tr_b16 v[54:55], v17 offset:25088
    v_mul_f32 v111, v87, v87
    v_fma_f32 v108, v108, v25, v24
    s_waitcnt lgkmcnt(9)
    v_mfma_f32_32x32x16_bf16 v[64:79], v[56:59], v[40:43], v[64:79]
    ds_read_b128 v[40:43], v10 offset:49152
    ds_read_b64_tr_b16 v[56:57], v18 offset:24576
    ds_read_b64_tr_b16 v[58:59], v18 offset:25088
    v_fma_f32 v109, v109, v25, v24
    v_fma_f32 v110, v110, v25, v24
    s_waitcnt lgkmcnt(9)
    v_mfma_f32_32x32x16_bf16 v[64:79], v[60:63], v[44:47], v[64:79]
    ds_read_b128 v[44:47], v11 offset:49152
    ds_read_b64_tr_b16 v[60:61], v19 offset:24576
    ds_read_b64_tr_b16 v[62:63], v19 offset:25088
    v_fma_f32 v111, v111, v25, v24
    v_mul_f32 v108, v84, v108
    v_mul_f32 v109, v85, v109
    s_waitcnt vmcnt(9)
    s_barrier
    s_waitcnt lgkmcnt(9)
    v_mfma_f32_32x32x16_bf16 v[64:79], v[48:51], v[32:35], v[64:79]
    ds_read_b128 v[32:35], v12 offset:0
    ds_read_b64_tr_b16 v[48:49], v16 offset:32768
    ds_read_b64_tr_b16 v[50:51], v16 offset:33280
    s_add_u32 m0, s52, 32768
    s_add_u32 s55, s48, 1792
    buffer_load_dwordx4 v2, s[20:23], s55 offen offset:0 lds
    buffer_load_dwordx4 v3, s[20:23], s55 offen offset:1024 lds
    s_add_u32 m0, s53, 16384
    s_add_u32 s56, s49, 114688
    buffer_load_dwordx4 v4, s[16:19], s56 offen lds
    v_mul_f32 v110, v86, v110
    v_mul_f32 v111, v87, v111
    s_waitcnt lgkmcnt(9)
    v_mfma_f32_32x32x16_bf16 v[64:79], v[52:55], v[36:39], v[64:79]
    ds_read_b128 v[36:39], v13 offset:0
    ds_read_b64_tr_b16 v[52:53], v17 offset:32768
    ds_read_b64_tr_b16 v[54:55], v17 offset:33280
    v_exp_f32 v108, v108
    v_exp_f32 v109, v109
    s_waitcnt lgkmcnt(9)
    v_mfma_f32_32x32x16_bf16 v[64:79], v[56:59], v[40:43], v[64:79]
    ds_read_b128 v[40:43], v14 offset:0
    ds_read_b64_tr_b16 v[56:57], v18 offset:32768
    ds_read_b64_tr_b16 v[58:59], v18 offset:33280
    v_exp_f32 v110, v110
    v_exp_f32 v111, v111
    s_waitcnt lgkmcnt(9)
    v_mfma_f32_32x32x16_bf16 v[64:79], v[60:63], v[44:47], v[64:79]
    ds_read_b128 v[44:47], v15 offset:0
    ds_read_b64_tr_b16 v[60:61], v19 offset:32768
    ds_read_b64_tr_b16 v[62:63], v19 offset:33280
    v_add_f32 v108, 1.0, v108
    v_add_f32 v109, 1.0, v109
    v_add_f32 v110, 1.0, v110
    s_waitcnt vmcnt(9)
    s_barrier
    s_waitcnt lgkmcnt(9)
    v_mfma_f32_32x32x16_bf16 v[64:79], v[48:51], v[32:35], v[64:79]
    ds_read_b128 v[32:35], v12 offset:16384
    ds_read_b64_tr_b16 v[48:49], v16 offset:40960
    ds_read_b64_tr_b16 v[50:51], v16 offset:41472
    s_add_u32 m0, s52, 49152
    s_add_u32 s55, s48, 1920
    buffer_load_dwordx4 v2, s[20:23], s55 offen offset:0 lds
    buffer_load_dwordx4 v3, s[20:23], s55 offen offset:1024 lds
    s_add_u32 m0, s53, 24576
    s_add_u32 s56, s49, 122880
    buffer_load_dwordx4 v4, s[16:19], s56 offen lds
    v_add_f32 v111, 1.0, v111
    v_rcp_f32 v108, v108
    s_waitcnt lgkmcnt(9)
    v_mfma_f32_32x32x16_bf16 v[64:79], v[52:55], v[36:39], v[64:79]
    ds_read_b128 v[36:39], v13 offset:16384
    ds_read_b64_tr_b16 v[52:53], v17 offset:40960
    ds_read_b64_tr_b16 v[54:55], v17 offset:41472
    v_rcp_f32 v109, v109
    v_rcp_f32 v110, v110
    s_waitcnt lgkmcnt(9)
    v_mfma_f32_32x32x16_bf16 v[64:79], v[56:59], v[40:43], v[64:79]
    ds_read_b128 v[40:43], v14 offset:16384
    ds_read_b64_tr_b16 v[56:57], v18 offset:40960
    ds_read_b64_tr_b16 v[58:59], v18 offset:41472
    v_rcp_f32 v111, v111
    v_mul_f32 v84, v84, v108
    v_mul_f32 v85, v85, v109
    s_waitcnt lgkmcnt(9)
    v_mfma_f32_32x32x16_bf16 v[64:79], v[60:63], v[44:47], v[64:79]
    ds_read_b128 v[44:47], v15 offset:16384
    ds_read_b64_tr_b16 v[60:61], v19 offset:40960
    ds_read_b64_tr_b16 v[62:63], v19 offset:41472
    v_mul_f32 v86, v86, v110
    v_mul_f32 v87, v87, v111
    s_waitcnt vmcnt(9)
    s_barrier
    s_waitcnt lgkmcnt(9)
    v_mfma_f32_32x32x16_bf16 v[64:79], v[48:51], v[32:35], v[64:79]
    ds_read_b128 v[32:35], v8 offset:0
    ds_read_b64_tr_b16 v[48:49], v16 offset:0
    ds_read_b64_tr_b16 v[50:51], v16 offset:512
    s_add_u32 m0, s52, 65536
    s_add_u32 s55, s48, 2048
    buffer_load_dwordx4 v2, s[20:23], s55 offen offset:0 lds
    buffer_load_dwordx4 v3, s[20:23], s55 offen offset:1024 lds
    s_add_u32 m0, s53, 32768
    s_add_u32 s56, s49, 131072
    buffer_load_dwordx4 v4, s[16:19], s56 offen lds
    v_lshlrev_b32 v88, 16, v100
    v_and_b32 v89, 0xffff0000, v100
    s_waitcnt lgkmcnt(9)
    v_mfma_f32_32x32x16_bf16 v[64:79], v[52:55], v[36:39], v[64:79]
    ds_read_b128 v[36:39], v9 offset:0
    ds_read_b64_tr_b16 v[52:53], v17 offset:0
    ds_read_b64_tr_b16 v[54:55], v17 offset:512
    v_lshlrev_b32 v90, 16, v101
    v_and_b32 v91, 0xffff0000, v101
    v_mul_f32 v104, v88, v88
    s_waitcnt lgkmcnt(9)
    v_mfma_f32_32x32x16_bf16 v[64:79], v[56:59], v[40:43], v[64:79]
    ds_read_b128 v[40:43], v10 offset:0
    ds_read_b64_tr_b16 v[56:57], v18 offset:0
    ds_read_b64_tr_b16 v[58:59], v18 offset:512
    v_mul_f32 v105, v89, v89
    v_mul_f32 v106, v90, v90
    s_waitcnt lgkmcnt(9)
    v_mfma_f32_32x32x16_bf16 v[64:79], v[60:63], v[44:47], v[64:79]
    ds_read_b128 v[44:47], v11 offset:0
    ds_read_b64_tr_b16 v[60:61], v19 offset:0
    ds_read_b64_tr_b16 v[62:63], v19 offset:512
    v_mul_f32 v107, v91, v91
    v_fma_f32 v104, v104, v25, v24
    s_waitcnt vmcnt(9)
    s_barrier
    s_waitcnt lgkmcnt(9)
    v_mfma_f32_32x32x16_bf16 v[64:79], v[48:51], v[32:35], v[64:79]
    ds_read_b128 v[32:35], v8 offset:16384
    ds_read_b64_tr_b16 v[48:49], v16 offset:8192
    ds_read_b64_tr_b16 v[50:51], v16 offset:8704
    s_add_u32 m0, s52, 81920
    s_add_u32 s55, s48, 2176
    buffer_load_dwordx4 v2, s[20:23], s55 offen offset:0 lds
    buffer_load_dwordx4 v3, s[20:23], s55 offen offset:1024 lds
    s_add_u32 m0, s53, 40960
    s_add_u32 s56, s49, 139264
    buffer_load_dwordx4 v4, s[16:19], s56 offen lds
    v_fma_f32 v105, v105, v25, v24
    v_fma_f32 v106, v106, v25, v24
    v_fma_f32 v107, v107, v25, v24
    s_waitcnt lgkmcnt(9)
    v_mfma_f32_32x32x16_bf16 v[64:79], v[52:55], v[36:39], v[64:79]
    ds_read_b128 v[36:39], v9 offset:16384
    ds_read_b64_tr_b16 v[52:53], v17 offset:8192
    ds_read_b64_tr_b16 v[54:55], v17 offset:8704
    v_mul_f32 v104, v88, v104
    v_mul_f32 v105, v89, v105
    s_waitcnt lgkmcnt(9)
    v_mfma_f32_32x32x16_bf16 v[64:79], v[56:59], v[40:43], v[64:79]
    ds_read_b128 v[40:43], v10 offset:16384
    ds_read_b64_tr_b16 v[56:57], v18 offset:8192
    ds_read_b64_tr_b16 v[58:59], v18 offset:8704
    v_mul_f32 v106, v90, v106
    v_mul_f32 v107, v91, v107
    s_waitcnt lgkmcnt(9)
    v_mfma_f32_32x32x16_bf16 v[64:79], v[60:63], v[44:47], v[64:79]
    ds_read_b128 v[44:47], v11 offset:16384
    ds_read_b64_tr_b16 v[60:61], v19 offset:8192
    ds_read_b64_tr_b16 v[62:63], v19 offset:8704
    v_exp_f32 v104, v104
    v_exp_f32 v105, v105
    s_waitcnt vmcnt(9)
    s_barrier
    s_waitcnt lgkmcnt(9)
    v_mfma_f32_32x32x16_bf16 v[64:79], v[48:51], v[32:35], v[64:79]
    ds_read_b128 v[32:35], v8 offset:32768
    ds_read_b64_tr_b16 v[48:49], v16 offset:16384
    ds_read_b64_tr_b16 v[50:51], v16 offset:16896
    s_add_u32 m0, s52, 0
    s_add_u32 s55, s48, 2304
    buffer_load_dwordx4 v2, s[20:23], s55 offen offset:0 lds
    buffer_load_dwordx4 v3, s[20:23], s55 offen offset:1024 lds
    s_add_u32 m0, s53, 0
    s_add_u32 s56, s49, 147456
    buffer_load_dwordx4 v4, s[16:19], s56 offen lds
    v_exp_f32 v106, v106
    v_exp_f32 v107, v107
    v_add_f32 v104, 1.0, v104
    s_waitcnt lgkmcnt(9)
    v_mfma_f32_32x32x16_bf16 v[64:79], v[52:55], v[36:39], v[64:79]
    ds_read_b128 v[36:39], v9 offset:32768
    ds_read_b64_tr_b16 v[52:53], v17 offset:16384
    ds_read_b64_tr_b16 v[54:55], v17 offset:16896
    v_add_f32 v105, 1.0, v105
    v_add_f32 v106, 1.0, v106
    s_waitcnt lgkmcnt(9)
    v_mfma_f32_32x32x16_bf16 v[64:79], v[56:59], v[40:43], v[64:79]
    ds_read_b128 v[40:43], v10 offset:32768
    ds_read_b64_tr_b16 v[56:57], v18 offset:16384
    ds_read_b64_tr_b16 v[58:59], v18 offset:16896
    v_add_f32 v107, 1.0, v107
    v_rcp_f32 v104, v104
    s_waitcnt lgkmcnt(9)
    v_mfma_f32_32x32x16_bf16 v[64:79], v[60:63], v[44:47], v[64:79]
    ds_read_b128 v[44:47], v11 offset:32768
    ds_read_b64_tr_b16 v[60:61], v19 offset:16384
    ds_read_b64_tr_b16 v[62:63], v19 offset:16896
    v_rcp_f32 v105, v105
    v_rcp_f32 v106, v106
    v_rcp_f32 v107, v107
    s_waitcnt vmcnt(9)
    s_barrier
    s_waitcnt lgkmcnt(9)
    v_mfma_f32_32x32x16_bf16 v[64:79], v[48:51], v[32:35], v[64:79]
    ds_read_b128 v[32:35], v8 offset:49152
    ds_read_b64_tr_b16 v[48:49], v16 offset:24576
    ds_read_b64_tr_b16 v[50:51], v16 offset:25088
    s_add_u32 m0, s52, 16384
    s_add_u32 s55, s48, 2432
    buffer_load_dwordx4 v2, s[20:23], s55 offen offset:0 lds
    buffer_load_dwordx4 v3, s[20:23], s55 offen offset:1024 lds
    s_add_u32 m0, s53, 8192
    s_add_u32 s56, s49, 155648
    buffer_load_dwordx4 v4, s[16:19], s56 offen lds
    v_mul_f32 v88, v88, v104
    v_mul_f32 v89, v89, v105
    s_waitcnt lgkmcnt(9)
    v_mfma_f32_32x32x16_bf16 v[64:79], v[52:55], v[36:39], v[64:79]
    ds_read_b128 v[36:39], v9 offset:49152
    ds_read_b64_tr_b16 v[52:53], v17 offset:24576
    ds_read_b64_tr_b16 v[54:55], v17 offset:25088
    v_mul_f32 v90, v90, v106
    v_mul_f32 v91, v91, v107
    s_waitcnt lgkmcnt(9)
    v_mfma_f32_32x32x16_bf16 v[64:79], v[56:59], v[40:43], v[64:79]
    ds_read_b128 v[40:43], v10 offset:49152
    ds_read_b64_tr_b16 v[56:57], v18 offset:24576
    ds_read_b64_tr_b16 v[58:59], v18 offset:25088
    v_lshlrev_b32 v92, 16, v102
    v_and_b32 v93, 0xffff0000, v102
    v_lshlrev_b32 v94, 16, v103
    s_waitcnt lgkmcnt(9)
    v_mfma_f32_32x32x16_bf16 v[64:79], v[60:63], v[44:47], v[64:79]
    ds_read_b128 v[44:47], v11 offset:49152
    ds_read_b64_tr_b16 v[60:61], v19 offset:24576
    ds_read_b64_tr_b16 v[62:63], v19 offset:25088
    v_and_b32 v95, 0xffff0000, v103
    v_mul_f32 v108, v92, v92
    s_waitcnt vmcnt(9)
    s_barrier
    s_waitcnt lgkmcnt(9)
    v_mfma_f32_32x32x16_bf16 v[64:79], v[48:51], v[32:35], v[64:79]
    ds_read_b128 v[32:35], v12 offset:0
    ds_read_b64_tr_b16 v[48:49], v16 offset:32768
    ds_read_b64_tr_b16 v[50:51], v16 offset:33280
    s_add_u32 m0, s52, 32768
    s_add_u32 s55, s48, 2560
    buffer_load_dwordx4 v2, s[20:23], s55 offen offset:0 lds
    buffer_load_dwordx4 v3, s[20:23], s55 offen offset:1024 lds
    s_add_u32 m0, s53, 16384
    s_add_u32 s56, s49, 163840
    buffer_load_dwordx4 v4, s[16:19], s56 offen lds
    v_mul_f32 v109, v93, v93
    v_mul_f32 v110, v94, v94
    s_waitcnt lgkmcnt(9)
    v_mfma_f32_32x32x16_bf16 v[64:79], v[52:55], v[36:39], v[64:79]
    ds_read_b128 v[36:39], v13 offset:0
    ds_read_b64_tr_b16 v[52:53], v17 offset:32768
    ds_read_b64_tr_b16 v[54:55], v17 offset:33280
    v_mul_f32 v111, v95, v95
    v_fma_f32 v108, v108, v25, v24
    s_waitcnt lgkmcnt(9)
    v_mfma_f32_32x32x16_bf16 v[64:79], v[56:59], v[40:43], v[64:79]
    ds_read_b128 v[40:43], v14 offset:0
    ds_read_b64_tr_b16 v[56:57], v18 offset:32768
    ds_read_b64_tr_b16 v[58:59], v18 offset:33280
    v_fma_f32 v109, v109, v25, v24
    v_fma_f32 v110, v110, v25, v24
    v_fma_f32 v111, v111, v25, v24
    s_waitcnt lgkmcnt(9)
    v_mfma_f32_32x32x16_bf16 v[64:79], v[60:63], v[44:47], v[64:79]
    ds_read_b128 v[44:47], v15 offset:0
    ds_read_b64_tr_b16 v[60:61], v19 offset:32768
    ds_read_b64_tr_b16 v[62:63], v19 offset:33280
    v_mul_f32 v108, v92, v108
    v_mul_f32 v109, v93, v109
    s_waitcnt vmcnt(9)
    s_barrier
    s_waitcnt lgkmcnt(9)
    v_mfma_f32_32x32x16_bf16 v[64:79], v[48:51], v[32:35], v[64:79]
    ds_read_b128 v[32:35], v12 offset:16384
    ds_read_b64_tr_b16 v[48:49], v16 offset:40960
    ds_read_b64_tr_b16 v[50:51], v16 offset:41472
    s_add_u32 m0, s52, 49152
    s_add_u32 s55, s48, 2688
    buffer_load_dwordx4 v2, s[20:23], s55 offen offset:0 lds
    buffer_load_dwordx4 v3, s[20:23], s55 offen offset:1024 lds
    s_add_u32 m0, s53, 24576
    s_add_u32 s56, s49, 172032
    buffer_load_dwordx4 v4, s[16:19], s56 offen lds
    v_mul_f32 v110, v94, v110
    v_mul_f32 v111, v95, v111
    s_waitcnt lgkmcnt(9)
    v_mfma_f32_32x32x16_bf16 v[64:79], v[52:55], v[36:39], v[64:79]
    ds_read_b128 v[36:39], v13 offset:16384
    ds_read_b64_tr_b16 v[52:53], v17 offset:40960
    ds_read_b64_tr_b16 v[54:55], v17 offset:41472
    v_exp_f32 v108, v108
    v_exp_f32 v109, v109
    v_exp_f32 v110, v110
    s_waitcnt lgkmcnt(9)
    v_mfma_f32_32x32x16_bf16 v[64:79], v[56:59], v[40:43], v[64:79]
    ds_read_b128 v[40:43], v14 offset:16384
    ds_read_b64_tr_b16 v[56:57], v18 offset:40960
    ds_read_b64_tr_b16 v[58:59], v18 offset:41472
    v_exp_f32 v111, v111
    v_add_f32 v108, 1.0, v108
    s_waitcnt lgkmcnt(9)
    v_mfma_f32_32x32x16_bf16 v[64:79], v[60:63], v[44:47], v[64:79]
    ds_read_b128 v[44:47], v15 offset:16384
    ds_read_b64_tr_b16 v[60:61], v19 offset:40960
    ds_read_b64_tr_b16 v[62:63], v19 offset:41472
    v_add_f32 v109, 1.0, v109
    v_add_f32 v110, 1.0, v110
    s_waitcnt vmcnt(9)
    s_barrier
    s_waitcnt lgkmcnt(9)
    v_mfma_f32_32x32x16_bf16 v[64:79], v[48:51], v[32:35], v[64:79]
    ds_read_b128 v[32:35], v8 offset:0
    ds_read_b64_tr_b16 v[48:49], v16 offset:0
    ds_read_b64_tr_b16 v[50:51], v16 offset:512
    s_add_u32 m0, s52, 65536
    s_add_u32 s55, s48, 2816
    buffer_load_dwordx4 v2, s[20:23], s55 offen offset:0 lds
    buffer_load_dwordx4 v3, s[20:23], s55 offen offset:1024 lds
    s_add_u32 m0, s53, 32768
    s_add_u32 s56, s49, 180224
    buffer_load_dwordx4 v4, s[16:19], s56 offen lds
    v_add_f32 v111, 1.0, v111
    v_rcp_f32 v108, v108
    v_rcp_f32 v109, v109
    s_waitcnt lgkmcnt(9)
    v_mfma_f32_32x32x16_bf16 v[64:79], v[52:55], v[36:39], v[64:79]
    ds_read_b128 v[36:39], v9 offset:0
    ds_read_b64_tr_b16 v[52:53], v17 offset:0
    ds_read_b64_tr_b16 v[54:55], v17 offset:512
    v_rcp_f32 v110, v110
    v_rcp_f32 v111, v111
    s_waitcnt lgkmcnt(9)
    v_mfma_f32_32x32x16_bf16 v[64:79], v[56:59], v[40:43], v[64:79]
    ds_read_b128 v[40:43], v10 offset:0
    ds_read_b64_tr_b16 v[56:57], v18 offset:0
    ds_read_b64_tr_b16 v[58:59], v18 offset:512
    v_mul_f32 v92, v92, v108
    v_mul_f32 v93, v93, v109
    s_waitcnt lgkmcnt(9)
    v_mfma_f32_32x32x16_bf16 v[64:79], v[60:63], v[44:47], v[64:79]
    ds_read_b128 v[44:47], v11 offset:0
    ds_read_b64_tr_b16 v[60:61], v19 offset:0
    ds_read_b64_tr_b16 v[62:63], v19 offset:512
    v_mul_f32 v94, v94, v110
    v_mul_f32 v95, v95, v111
    v_lshlrev_b32 v20, 16, v20
    s_waitcnt vmcnt(9)
    s_barrier
    s_waitcnt lgkmcnt(9)
    v_mfma_f32_32x32x16_bf16 v[64:79], v[48:51], v[32:35], v[64:79]
    ds_read_b128 v[32:35], v8 offset:16384
    ds_read_b64_tr_b16 v[48:49], v16 offset:8192
    ds_read_b64_tr_b16 v[50:51], v16 offset:8704
    s_add_u32 m0, s52, 81920
    s_add_u32 s55, s48, 2944
    buffer_load_dwordx4 v2, s[20:23], s55 offen offset:0 lds
    buffer_load_dwordx4 v3, s[20:23], s55 offen offset:1024 lds
    s_add_u32 m0, s53, 40960
    s_add_u32 s56, s49, 188416
    buffer_load_dwordx4 v4, s[16:19], s56 offen lds
    s_and_b32 s62, s2, 7
    s_lshr_b32 s63, s2, 3
    s_lshl_b32 s62, s62, 2
    s_waitcnt lgkmcnt(9)
    v_mfma_f32_32x32x16_bf16 v[64:79], v[52:55], v[36:39], v[64:79]
    ds_read_b128 v[36:39], v9 offset:16384
    ds_read_b64_tr_b16 v[52:53], v17 offset:8192
    ds_read_b64_tr_b16 v[54:55], v17 offset:8704
    s_and_b32 s92, s63, 3
    s_add_u32 s92, s92, s62
    s_lshr_b32 s93, s63, 2
    s_waitcnt lgkmcnt(9)
    v_mfma_f32_32x32x16_bf16 v[64:79], v[56:59], v[40:43], v[64:79]
    ds_read_b128 v[40:43], v10 offset:16384
    ds_read_b64_tr_b16 v[56:57], v18 offset:8192
    ds_read_b64_tr_b16 v[58:59], v18 offset:8704
    s_lshl_b32 s97, s92, 6
    s_and_b32 s95, s42, 1
    s_lshr_b32 s96, s42, 1
    s_and_b32 s96, s96, 1
    s_waitcnt lgkmcnt(9)
    v_mfma_f32_32x32x16_bf16 v[64:79], v[60:63], v[44:47], v[64:79]
    ds_read_b128 v[44:47], v11 offset:16384
    ds_read_b64_tr_b16 v[60:61], v19 offset:8192
    ds_read_b64_tr_b16 v[62:63], v19 offset:8704
    s_lshr_b32 s94, s42, 2
    v_lshrrev_b32 v152, 3, v1
    v_lshrrev_b32 v153, 4, v1
    s_waitcnt vmcnt(9)
    s_barrier
    s_waitcnt lgkmcnt(9)
    v_mfma_f32_32x32x16_bf16 v[64:79], v[48:51], v[32:35], v[64:79]
    ds_read_b128 v[32:35], v8 offset:32768
    ds_read_b64_tr_b16 v[48:49], v16 offset:16384
    ds_read_b64_tr_b16 v[50:51], v16 offset:16896
    s_add_u32 m0, s52, 0
    s_add_u32 s55, s48, 3072
    buffer_load_dwordx4 v2, s[20:23], s55 offen offset:0 lds
    buffer_load_dwordx4 v3, s[20:23], s55 offen offset:1024 lds
    s_add_u32 m0, s53, 0
    s_add_u32 s56, s49, 196608
    buffer_load_dwordx4 v4, s[16:19], s56 offen lds
    v_and_b32 v154, 7, v1
    v_and_b32 v155, 1, v153
    v_lshlrev_b32 v155, 2, v155
    v_xor_b32 v155, v154, v155
    s_waitcnt lgkmcnt(9)
    v_mfma_f32_32x32x16_bf16 v[64:79], v[52:55], v[36:39], v[64:79]
    ds_read_b128 v[36:39], v9 offset:32768
    ds_read_b64_tr_b16 v[52:53], v17 offset:16384
    ds_read_b64_tr_b16 v[54:55], v17 offset:16896
    v_lshlrev_b32 v155, 4, v155
    v_mul_u32_u24 v129, 896, v152
    v_add_u32 v129, v129, v155
    s_waitcnt lgkmcnt(9)
    v_mfma_f32_32x32x16_bf16 v[64:79], v[56:59], v[40:43], v[64:79]
    ds_read_b128 v[40:43], v10 offset:32768
    ds_read_b64_tr_b16 v[56:57], v18 offset:16384
    ds_read_b64_tr_b16 v[58:59], v18 offset:16896
    s_lshl_b32 s62, s95, 2
    v_add_u32 v153, s62, v153
    v_xor_b32 v155, v154, v153
    s_waitcnt lgkmcnt(9)
    v_mfma_f32_32x32x16_bf16 v[64:79], v[60:63], v[44:47], v[64:79]
    ds_read_b128 v[44:47], v11 offset:32768
    ds_read_b64_tr_b16 v[60:61], v19 offset:16384
    ds_read_b64_tr_b16 v[62:63], v19 offset:16896
    v_lshlrev_b32 v155, 4, v155
    v_mul_u32_u24 v128, 128, v152
    v_add_u32 v128, v128, v155
    v_mul_u32_u24 v130, 896, v152
    s_waitcnt vmcnt(9)
    s_barrier
    s_waitcnt lgkmcnt(9)
    v_mfma_f32_32x32x16_bf16 v[64:79], v[48:51], v[32:35], v[64:79]
    ds_read_b128 v[32:35], v8 offset:49152
    ds_read_b64_tr_b16 v[48:49], v16 offset:24576
    ds_read_b64_tr_b16 v[50:51], v16 offset:25088
    s_add_u32 m0, s52, 16384
    s_add_u32 s55, s48, 3200
    buffer_load_dwordx4 v2, s[20:23], s55 offen offset:0 lds
    buffer_load_dwordx4 v3, s[20:23], s55 offen offset:1024 lds
    s_add_u32 m0, s53, 8192
    s_add_u32 s56, s49, 204800
    buffer_load_dwordx4 v4, s[16:19], s56 offen lds
    v_add_u32 v130, v130, v155
    s_lshl_b32 s62, s42, 3
    s_add_u32 s63, s62, s97
    s_waitcnt lgkmcnt(9)
    v_mfma_f32_32x32x16_bf16 v[64:79], v[52:55], v[36:39], v[64:79]
    ds_read_b128 v[36:39], v9 offset:49152
    ds_read_b64_tr_b16 v[52:53], v17 offset:24576
    ds_read_b64_tr_b16 v[54:55], v17 offset:25088
    s_mul_i32 s98, s63, 128
    s_add_u32 s98, s98, 14680064
    s_mul_i32 s100, s63, 896
    s_mul_i32 s99, s62, 896
    s_waitcnt lgkmcnt(9)
    v_mfma_f32_32x32x16_bf16 v[64:79], v[56:59], v[40:43], v[64:79]
    ds_read_b128 v[40:43], v10 offset:49152
    ds_read_b64_tr_b16 v[56:57], v18 offset:24576
    ds_read_b64_tr_b16 v[58:59], v18 offset:25088
    s_lshl_b32 s63, s93, 7
    s_add_u32 s99, s99, s63
    s_add_u32 s100, s100, s63
    s_waitcnt lgkmcnt(9)
    v_mfma_f32_32x32x16_bf16 v[64:79], v[60:63], v[44:47], v[64:79]
    ds_read_b128 v[44:47], v11 offset:49152
    ds_read_b64_tr_b16 v[60:61], v19 offset:24576
    ds_read_b64_tr_b16 v[62:63], v19 offset:25088
    s_lshl_b32 s101, s42, 10
    v_lshlrev_b32 v150, 2, v1
    v_lshlrev_b32 v196, 4, v0
    v_add_u32 v197, 0x10000, v196
    s_waitcnt vmcnt(9)
    s_barrier
    s_waitcnt lgkmcnt(9)
    v_mfma_f32_32x32x16_bf16 v[64:79], v[48:51], v[32:35], v[64:79]
    ds_read_b128 v[32:35], v12 offset:0
    ds_read_b64_tr_b16 v[48:49], v16 offset:32768
    ds_read_b64_tr_b16 v[50:51], v16 offset:33280
    s_add_u32 m0, s52, 32768
    s_add_u32 s55, s48, 3328
    buffer_load_dwordx4 v2, s[20:23], s55 offen offset:0 lds
    buffer_load_dwordx4 v3, s[20:23], s55 offen offset:1024 lds
    s_add_u32 m0, s53, 16384
    s_add_u32 s56, s49, 212992
    buffer_load_dwordx4 v4, s[16:19], s56 offen lds
    v_and_b32 v156, 31, v1
    v_lshrrev_b32 v157, 5, v1
    s_waitcnt lgkmcnt(9)
    v_mfma_f32_32x32x16_bf16 v[64:79], v[52:55], v[36:39], v[64:79]
    ds_read_b128 v[36:39], v13 offset:0
    ds_read_b64_tr_b16 v[52:53], v17 offset:32768
    ds_read_b64_tr_b16 v[54:55], v17 offset:33280
    v_and_b32 v158, 15, v1
    v_and_b32 v159, 3, v158
    v_lshlrev_b32 v159, 3, v159
    s_add_u32 m0, s101, 147456
    s_nop 0
    buffer_load_dwordx4 v130, s[4:7], s100 offen lds
    s_waitcnt lgkmcnt(9)
    v_mfma_f32_32x32x16_bf16 v[64:79], v[56:59], v[40:43], v[64:79]
    ds_read_b128 v[40:43], v14 offset:0
    ds_read_b64_tr_b16 v[56:57], v18 offset:32768
    ds_read_b64_tr_b16 v[58:59], v18 offset:33280
    v_lshrrev_b32 v158, 2, v158
    v_lshrrev_b32 v160, 4, v1
    v_and_b32 v160, 1, v160
    s_waitcnt lgkmcnt(9)
    v_mfma_f32_32x32x16_bf16 v[64:79], v[60:63], v[44:47], v[64:79]
    ds_read_b128 v[44:47], v15 offset:0
    ds_read_b64_tr_b16 v[60:61], v19 offset:32768
    ds_read_b64_tr_b16 v[62:63], v19 offset:33280
    v_lshlrev_b32 v160, 5, v160
    v_add_u32 v160, v160, v159
    v_lshlrev_b32 v161, 3, v157
    s_waitcnt vmcnt(10)
    s_barrier
    s_waitcnt lgkmcnt(9)
    v_mfma_f32_32x32x16_bf16 v[64:79], v[48:51], v[32:35], v[64:79]
    ds_read_b128 v[32:35], v12 offset:16384
    ds_read_b64_tr_b16 v[48:49], v16 offset:40960
    ds_read_b64_tr_b16 v[50:51], v16 offset:41472
    s_add_u32 m0, s52, 49152
    s_add_u32 s55, s48, 3456
    buffer_load_dwordx4 v2, s[20:23], s55 offen offset:0 lds
    buffer_load_dwordx4 v3, s[20:23], s55 offen offset:1024 lds
    s_add_u32 m0, s53, 24576
    s_add_u32 s56, s49, 221184
    buffer_load_dwordx4 v4, s[16:19], s56 offen lds
    v_add_u32 v161, v161, v158
    v_lshlrev_b32 v161, 7, v161
    v_add_u32 v161, v161, v160
    s_waitcnt lgkmcnt(9)
    v_mfma_f32_32x32x16_bf16 v[64:79], v[52:55], v[36:39], v[64:79]
    ds_read_b128 v[36:39], v13 offset:16384
    ds_read_b64_tr_b16 v[52:53], v17 offset:40960
    ds_read_b64_tr_b16 v[54:55], v17 offset:41472
    v_lshrrev_b32 v158, 1, v158
    v_xor_b32 v158, s96, v158
    v_lshlrev_b32 v158, 6, v158
    s_waitcnt lgkmcnt(9)
    v_mfma_f32_32x32x16_bf16 v[64:79], v[56:59], v[40:43], v[64:79]
    ds_read_b128 v[40:43], v14 offset:16384
    ds_read_b64_tr_b16 v[56:57], v18 offset:40960
    ds_read_b64_tr_b16 v[58:59], v18 offset:41472
    v_add_u32 v161, v161, v158
    v_lshrrev_b32 v159, 1, v156
    v_and_b32 v159, 7, v159
    s_waitcnt lgkmcnt(9)
    v_mfma_f32_32x32x16_bf16 v[64:79], v[60:63], v[44:47], v[64:79]
    ds_read_b128 v[44:47], v15 offset:16384
    ds_read_b64_tr_b16 v[60:61], v19 offset:40960
    ds_read_b64_tr_b16 v[62:63], v19 offset:41472
    s_lshl_b32 s62, s95, 5
    v_add_u32 v156, s62, v156
    v_lshlrev_b32 v160, 7, v156
    s_waitcnt vmcnt(10)
    s_barrier
    s_waitcnt lgkmcnt(9)
    v_mfma_f32_32x32x16_bf16 v[64:79], v[48:51], v[32:35], v[64:79]
    ds_read_b128 v[32:35], v8 offset:0
    ds_read_b64_tr_b16 v[48:49], v16 offset:0
    ds_read_b64_tr_b16 v[50:51], v16 offset:512
    s_add_u32 m0, s52, 65536
    s_add_u32 s55, s48, 3584
    buffer_load_dwordx4 v2, s[20:23], s55 offen offset:0 lds
    buffer_load_dwordx4 v3, s[20:23], s55 offen offset:1024 lds
    s_add_u32 m0, s53, 32768
    s_add_u32 s56, s49, 229376
    buffer_load_dwordx4 v4, s[16:19], s56 offen lds
    s_lshl_b32 s62, s94, 1
    s_add_u32 s62, s62, 0
    s_lshl_b32 s63, s62, 1
    s_waitcnt lgkmcnt(9)
    v_mfma_f32_32x32x16_bf16 v[64:79], v[52:55], v[36:39], v[64:79]
    ds_read_b128 v[36:39], v9 offset:0
    ds_read_b64_tr_b16 v[52:53], v17 offset:0
    ds_read_b64_tr_b16 v[54:55], v17 offset:512
    v_add_u32 v158, s63, v157
    v_xor_b32 v158, v158, v159
    v_lshlrev_b32 v158, 4, v158
    s_waitcnt lgkmcnt(9)
    v_mfma_f32_32x32x16_bf16 v[64:79], v[56:59], v[40:43], v[64:79]
    ds_read_b128 v[40:43], v10 offset:0
    ds_read_b64_tr_b16 v[56:57], v18 offset:0
    ds_read_b64_tr_b16 v[58:59], v18 offset:512
    v_add_u32 v132, v160, v158
    v_add_u32 v134, 0x10000, v132
    s_lshl_b32 s63, s62, 11
    s_waitcnt lgkmcnt(9)
    v_mfma_f32_32x32x16_bf16 v[64:79], v[60:63], v[44:47], v[64:79]
    ds_read_b128 v[44:47], v11 offset:0
    ds_read_b64_tr_b16 v[60:61], v19 offset:0
    ds_read_b64_tr_b16 v[62:63], v19 offset:512
    v_add_u32 v136, s63, v161
    v_add_u32 v138, 0x10000, v136
    v_add_u32 v140, 0x20000, v136
    s_waitcnt vmcnt(10)
    s_barrier
    s_waitcnt lgkmcnt(9)
    v_mfma_f32_32x32x16_bf16 v[64:79], v[48:51], v[32:35], v[64:79]
    ds_read_b128 v[32:35], v8 offset:16384
    ds_read_b64_tr_b16 v[48:49], v16 offset:8192
    ds_read_b64_tr_b16 v[50:51], v16 offset:8704
    s_add_u32 m0, s52, 81920
    s_add_u32 s55, s48, 3712
    buffer_load_dwordx4 v2, s[20:23], s55 offen offset:0 lds
    buffer_load_dwordx4 v3, s[20:23], s55 offen offset:1024 lds
    s_add_u32 m0, s53, 40960
    s_add_u32 s56, s49, 237568
    buffer_load_dwordx4 v4, s[16:19], s56 offen lds
    s_lshl_b32 s62, s94, 1
    s_add_u32 s62, s62, 1
    s_lshl_b32 s63, s62, 1
    s_waitcnt lgkmcnt(9)
    v_mfma_f32_32x32x16_bf16 v[64:79], v[52:55], v[36:39], v[64:79]
    ds_read_b128 v[36:39], v9 offset:16384
    ds_read_b64_tr_b16 v[52:53], v17 offset:8192
    ds_read_b64_tr_b16 v[54:55], v17 offset:8704
    v_add_u32 v158, s63, v157
    v_xor_b32 v158, v158, v159
    v_lshlrev_b32 v158, 4, v158
    s_waitcnt lgkmcnt(9)
    v_mfma_f32_32x32x16_bf16 v[64:79], v[56:59], v[40:43], v[64:79]
    ds_read_b128 v[40:43], v10 offset:16384
    ds_read_b64_tr_b16 v[56:57], v18 offset:8192
    ds_read_b64_tr_b16 v[58:59], v18 offset:8704
    v_add_u32 v133, v160, v158
    v_add_u32 v135, 0x10000, v133
    s_lshl_b32 s63, s62, 11
    s_waitcnt lgkmcnt(9)
    v_mfma_f32_32x32x16_bf16 v[64:79], v[60:63], v[44:47], v[64:79]
    ds_read_b128 v[44:47], v11 offset:16384
    ds_read_b64_tr_b16 v[60:61], v19 offset:8192
    ds_read_b64_tr_b16 v[62:63], v19 offset:8704
    v_add_u32 v137, s63, v161
    v_add_u32 v139, 0x10000, v137
    v_add_u32 v141, 0x20000, v137
    s_waitcnt vmcnt(10)
    s_barrier
    s_waitcnt lgkmcnt(9)
    v_mfma_f32_32x32x16_bf16 v[64:79], v[48:51], v[32:35], v[64:79]
    ds_read_b128 v[32:35], v8 offset:32768
    ds_read_b64_tr_b16 v[48:49], v16 offset:16384
    ds_read_b64_tr_b16 v[50:51], v16 offset:16896
    s_add_u32 m0, s52, 0
    s_add_u32 s55, s48, 3840
    buffer_load_dwordx4 v2, s[20:23], s55 offen offset:0 lds
    buffer_load_dwordx4 v3, s[20:23], s55 offen offset:1024 lds
    s_add_u32 m0, s53, 0
    s_add_u32 s56, s49, 245760
    buffer_load_dwordx4 v4, s[16:19], s56 offen lds
    s_and_b32 s62, s42, 3
    s_lshl_b32 s62, s62, 12
    s_waitcnt lgkmcnt(9)
    v_mfma_f32_32x32x16_bf16 v[64:79], v[52:55], v[36:39], v[64:79]
    ds_read_b128 v[36:39], v9 offset:32768
    ds_read_b64_tr_b16 v[52:53], v17 offset:16384
    ds_read_b64_tr_b16 v[54:55], v17 offset:16896
    s_lshl_b32 s63, s94, 11
    s_add_u32 s60, s62, s63
    s_waitcnt lgkmcnt(9)
    v_mfma_f32_32x32x16_bf16 v[64:79], v[56:59], v[40:43], v[64:79]
    ds_read_b128 v[40:43], v10 offset:32768
    ds_read_b64_tr_b16 v[56:57], v18 offset:16384
    ds_read_b64_tr_b16 v[58:59], v18 offset:16896
    s_xor_b32 s63, s63, 2048
    s_add_u32 s61, s62, s63
    s_waitcnt lgkmcnt(9)
    v_mfma_f32_32x32x16_bf16 v[64:79], v[60:63], v[44:47], v[64:79]
    ds_read_b128 v[44:47], v11 offset:32768
    ds_read_b64_tr_b16 v[60:61], v19 offset:16384
    ds_read_b64_tr_b16 v[62:63], v19 offset:16896
    v_lshlrev_b32 v152, 4, v1
    v_add_u32 v142, s60, v152
    s_waitcnt vmcnt(9)
    s_barrier
    s_waitcnt lgkmcnt(9)
    v_mfma_f32_32x32x16_bf16 v[64:79], v[48:51], v[32:35], v[64:79]
    ds_read_b128 v[32:35], v8 offset:49152
    ds_read_b64_tr_b16 v[48:49], v16 offset:24576
    ds_read_b64_tr_b16 v[50:51], v16 offset:25088
    s_add_u32 m0, s52, 16384
    s_add_u32 s55, s48, 3968
    buffer_load_dwordx4 v2, s[20:23], s55 offen offset:0 lds
    buffer_load_dwordx4 v3, s[20:23], s55 offen offset:1024 lds
    s_add_u32 m0, s53, 8192
    s_add_u32 s56, s49, 253952
    buffer_load_dwordx4 v4, s[16:19], s56 offen lds
    v_add_u32 v143, s61, v152
    v_and_b32 v152, 31, v1
    s_waitcnt lgkmcnt(9)
    v_mfma_f32_32x32x16_bf16 v[64:79], v[52:55], v[36:39], v[64:79]
    ds_read_b128 v[36:39], v9 offset:49152
    ds_read_b64_tr_b16 v[52:53], v17 offset:24576
    ds_read_b64_tr_b16 v[54:55], v17 offset:25088
    v_lshrrev_b32 v153, 5, v1
    s_lshl_b32 s62, s95, 5
    s_waitcnt lgkmcnt(9)
    v_mfma_f32_32x32x16_bf16 v[64:79], v[56:59], v[40:43], v[64:79]
    ds_read_b128 v[40:43], v10 offset:49152
    ds_read_b64_tr_b16 v[56:57], v18 offset:24576
    ds_read_b64_tr_b16 v[58:59], v18 offset:25088
    v_add_u32 v154, s62, v152
    v_lshlrev_b32 v153, 3, v153
    s_waitcnt lgkmcnt(9)
    v_mfma_f32_32x32x16_bf16 v[64:79], v[60:63], v[44:47], v[64:79]
    ds_read_b128 v[44:47], v11 offset:49152
    ds_read_b64_tr_b16 v[60:61], v19 offset:24576
    ds_read_b64_tr_b16 v[62:63], v19 offset:25088
    s_lshl_b32 s63, s96, 6
    s_lshl_b32 s60, s94, 5
    s_add_u32 s63, s63, s60
    s_waitcnt vmcnt(9)
    s_barrier
    s_waitcnt lgkmcnt(9)
    v_mfma_f32_32x32x16_bf16 v[64:79], v[48:51], v[32:35], v[64:79]
    ds_read_b128 v[32:35], v12 offset:0
    ds_read_b64_tr_b16 v[48:49], v16 offset:32768
    ds_read_b64_tr_b16 v[50:51], v16 offset:33280
    v_lshrrev_b32 v152, 1, v152
    v_and_b32 v152, 7, v152
    s_waitcnt lgkmcnt(9)
    v_mfma_f32_32x32x16_bf16 v[64:79], v[52:55], v[36:39], v[64:79]
    ds_read_b128 v[36:39], v13 offset:0
    ds_read_b64_tr_b16 v[52:53], v17 offset:32768
    ds_read_b64_tr_b16 v[54:55], v17 offset:33280
    v_lshlrev_b32 v152, 4, v152
    v_xor_b32 v152, s63, v152
    s_waitcnt lgkmcnt(9)
    v_mfma_f32_32x32x16_bf16 v[64:79], v[56:59], v[40:43], v[64:79]
    ds_read_b128 v[40:43], v14 offset:0
    ds_read_b64_tr_b16 v[56:57], v18 offset:32768
    ds_read_b64_tr_b16 v[58:59], v18 offset:33280
    s_add_u32 m0, s101, 114688
    s_add_u32 s56, s99, 0
    buffer_load_dwordx4 v129, s[28:31], s56 offen lds
    v_lshl_add_u32 v144, v154, 7, v152
    v_add_u32 v144, v144, v153
    s_waitcnt lgkmcnt(9)
    v_mfma_f32_32x32x16_bf16 v[64:79], v[60:63], v[44:47], v[64:79]
    ds_read_b128 v[44:47], v15 offset:0
    ds_read_b64_tr_b16 v[60:61], v19 offset:32768
    ds_read_b64_tr_b16 v[62:63], v19 offset:33280
    v_add_u32 v144, 147456, v144
    v_xor_b32 v145, 16, v144
    s_waitcnt vmcnt(7)
    s_barrier
    s_waitcnt lgkmcnt(9)
    v_mfma_f32_32x32x16_bf16 v[64:79], v[48:51], v[32:35], v[64:79]
    ds_read_b128 v[32:35], v12 offset:16384
    ds_read_b64_tr_b16 v[48:49], v16 offset:40960
    ds_read_b64_tr_b16 v[50:51], v16 offset:41472
    v_mul_u32_u24 v146, 144, v154
    v_add3_u32 v146, v146, v153, s63
    s_waitcnt lgkmcnt(9)
    v_mfma_f32_32x32x16_bf16 v[64:79], v[52:55], v[36:39], v[64:79]
    ds_read_b128 v[36:39], v13 offset:16384
    ds_read_b64_tr_b16 v[52:53], v17 offset:40960
    ds_read_b64_tr_b16 v[54:55], v17 offset:41472
    v_lshrrev_b32 v152, 3, v0
    v_and_b32 v153, 7, v0
    s_waitcnt lgkmcnt(9)
    v_mfma_f32_32x32x16_bf16 v[64:79], v[56:59], v[40:43], v[64:79]
    ds_read_b128 v[40:43], v14 offset:16384
    ds_read_b64_tr_b16 v[56:57], v18 offset:40960
    ds_read_b64_tr_b16 v[58:59], v18 offset:41472
    s_add_u32 m0, s101, 122880
    s_add_u32 s56, s99, 57344
    buffer_load_dwordx4 v129, s[28:31], s56 offen lds
    v_lshlrev_b32 v153, 4, v153
    v_mul_u32_u24 v147, 144, v152
    s_waitcnt lgkmcnt(9)
    v_mfma_f32_32x32x16_bf16 v[64:79], v[60:63], v[44:47], v[64:79]
    ds_read_b128 v[44:47], v15 offset:16384
    ds_read_b64_tr_b16 v[60:61], v19 offset:40960
    ds_read_b64_tr_b16 v[62:63], v19 offset:41472
    v_add_u32 v147, v147, v153
    v_mul_u32_u24 v148, 896, v152
    v_add_u32 v148, v148, v153
    s_waitcnt vmcnt(5)
    s_barrier
    s_waitcnt lgkmcnt(9)
    v_mfma_f32_32x32x16_bf16 v[64:79], v[48:51], v[32:35], v[64:79]
    ds_read_b128 v[32:35], v8 offset:0
    ds_read_b64_tr_b16 v[48:49], v16 offset:0
    ds_read_b64_tr_b16 v[50:51], v16 offset:512
    s_waitcnt lgkmcnt(9)
    v_mfma_f32_32x32x16_bf16 v[64:79], v[52:55], v[36:39], v[64:79]
    ds_read_b128 v[36:39], v9 offset:0
    ds_read_b64_tr_b16 v[52:53], v17 offset:0
    ds_read_b64_tr_b16 v[54:55], v17 offset:512
    s_waitcnt lgkmcnt(9)
    v_mfma_f32_32x32x16_bf16 v[64:79], v[56:59], v[40:43], v[64:79]
    ds_read_b128 v[40:43], v10 offset:0
    ds_read_b64_tr_b16 v[56:57], v18 offset:0
    ds_read_b64_tr_b16 v[58:59], v18 offset:512
    s_add_u32 m0, s101, 131072
    s_add_u32 s56, s99, 114688
    buffer_load_dwordx4 v129, s[28:31], s56 offen lds
    s_waitcnt lgkmcnt(9)
    v_mfma_f32_32x32x16_bf16 v[64:79], v[60:63], v[44:47], v[64:79]
    ds_read_b128 v[44:47], v11 offset:0
    ds_read_b64_tr_b16 v[60:61], v19 offset:0
    ds_read_b64_tr_b16 v[62:63], v19 offset:512
    s_waitcnt vmcnt(3)
    s_barrier
    s_waitcnt lgkmcnt(9)
    v_mfma_f32_32x32x16_bf16 v[64:79], v[48:51], v[32:35], v[64:79]
    ds_read_b128 v[32:35], v8 offset:16384
    ds_read_b64_tr_b16 v[48:49], v16 offset:8192
    ds_read_b64_tr_b16 v[50:51], v16 offset:8704
    s_waitcnt lgkmcnt(9)
    v_mfma_f32_32x32x16_bf16 v[64:79], v[52:55], v[36:39], v[64:79]
    ds_read_b128 v[36:39], v9 offset:16384
    ds_read_b64_tr_b16 v[52:53], v17 offset:8192
    ds_read_b64_tr_b16 v[54:55], v17 offset:8704
    s_waitcnt lgkmcnt(9)
    v_mfma_f32_32x32x16_bf16 v[64:79], v[56:59], v[40:43], v[64:79]
    ds_read_b128 v[40:43], v10 offset:16384
    ds_read_b64_tr_b16 v[56:57], v18 offset:8192
    ds_read_b64_tr_b16 v[58:59], v18 offset:8704
    s_add_u32 m0, s101, 139264
    s_add_u32 s56, s99, 172032
    buffer_load_dwordx4 v129, s[28:31], s56 offen lds
    s_waitcnt lgkmcnt(9)
    v_mfma_f32_32x32x16_bf16 v[64:79], v[60:63], v[44:47], v[64:79]
    ds_read_b128 v[44:47], v11 offset:16384
    ds_read_b64_tr_b16 v[60:61], v19 offset:8192
    ds_read_b64_tr_b16 v[62:63], v19 offset:8704
    s_barrier
    s_waitcnt lgkmcnt(9)
    v_mfma_f32_32x32x16_bf16 v[64:79], v[48:51], v[32:35], v[64:79]
    s_add_u32 m0, s101, 98304
    s_add_u32 s56, s99, 229376
    buffer_load_dwordx4 v129, s[28:31], s56 offen lds
    s_cmp_lg_u32 s42, 0
    s_cbranch_scc1 pi_f_15
    s_lshl_b32 s50, s92, 7
    s_add_u32 s50, s50, 22024192
    s_mov_b32 exec_lo, 1
    s_mov_b32 exec_hi, 0
    buffer_load_dword v151, v150, s[16:19], s50 offen sc1
    s_mov_b64 exec, -1
pi_f_15:
    s_waitcnt lgkmcnt(6)
    v_mfma_f32_32x32x16_bf16 v[64:79], v[52:55], v[36:39], v[64:79]
    s_waitcnt lgkmcnt(3)
    v_mfma_f32_32x32x16_bf16 v[64:79], v[56:59], v[40:43], v[64:79]
    s_add_u32 m0, s101, 0
    s_add_u32 s56, s99, 344064
    buffer_load_dwordx4 v129, s[28:31], s56 offen lds
    s_add_u32 m0, s101, 8192
    s_add_u32 s56, s99, 0
    buffer_load_dwordx4 v129, s[24:27], s56 offen lds
    s_waitcnt lgkmcnt(0)
    v_mfma_f32_32x32x16_bf16 v[64:79], v[60:63], v[44:47], v[64:79]
    s_nop 11
    v_add_f32 v64, v64, v20
    v_add_f32 v65, v65, v20
    v_add_f32 v66, v66, v20
    v_add_f32 v67, v67, v20
    v_mul_f32 v64, v64, v80
    v_mul_f32 v65, v65, v81
    v_mul_f32 v66, v66, v82
    v_mul_f32 v67, v67, v83
    v_cvt_pk_bf16_f32 v104, v64, v65
    v_cvt_pk_bf16_f32 v105, v66, v67
    ds_write_b64 v21, v[104:105]
    v_add_f32 v68, v68, v20
    v_add_f32 v69, v69, v20
    v_add_f32 v70, v70, v20
    v_add_f32 v71, v71, v20
    v_mul_f32 v68, v68, v84
    v_mul_f32 v69, v69, v85
    v_mul_f32 v70, v70, v86
    v_mul_f32 v71, v71, v87
    v_cvt_pk_bf16_f32 v106, v68, v69
    v_cvt_pk_bf16_f32 v107, v70, v71
    ds_write_b64 v26, v[106:107]
    v_add_f32 v72, v72, v20
    v_add_f32 v73, v73, v20
    v_add_f32 v74, v74, v20
    v_add_f32 v75, v75, v20
    v_mul_f32 v72, v72, v88
    v_mul_f32 v73, v73, v89
    v_mul_f32 v74, v74, v90
    v_mul_f32 v75, v75, v91
    v_cvt_pk_bf16_f32 v108, v72, v73
    v_cvt_pk_bf16_f32 v109, v74, v75
    ds_write_b64 v27, v[108:109]
    v_add_f32 v76, v76, v20
    v_add_f32 v77, v77, v20
    v_add_f32 v78, v78, v20
    v_add_f32 v79, v79, v20
    v_mul_f32 v76, v76, v92
    v_mul_f32 v77, v77, v93
    v_mul_f32 v78, v78, v94
    v_mul_f32 v79, v79, v95
    v_cvt_pk_bf16_f32 v110, v76, v77
    v_cvt_pk_bf16_f32 v111, v78, v79
    ds_write_b64 v28, v[110:111]
    s_lshl_b32 s57, s42, 4
    s_add_u32 s57, s57, s47
    s_mul_i32 s57, s57, 128
    s_lshl_b32 s58, s46, 18
    s_add_u32 s57, s57, s58
    s_add_u32 s57, s57, 14680064
    s_add_u32 s58, s57, 1024
    s_waitcnt lgkmcnt(0)
    s_barrier
    ds_read_b128 v[80:83], v22
    ds_read_b128 v[84:87], v29 offset:1024
    s_waitcnt lgkmcnt(1)
    buffer_store_dwordx4 v[80:83], v23, s[16:19], s57 offen sc1
    s_waitcnt lgkmcnt(0)
    buffer_store_dwordx4 v[84:87], v23, s[16:19], s58 offen sc1
    s_add_u32 m0, s101, 106496
    s_add_u32 s56, s99, 286720
    buffer_load_dwordx4 v129, s[28:31], s56 offen lds
    s_add_u32 m0, s101, 16384
    s_add_u32 s56, s99, 57344
    buffer_load_dwordx4 v129, s[24:27], s56 offen lds
    s_add_u32 m0, s101, 24576
    s_add_u32 s56, s99, 114688
    buffer_load_dwordx4 v129, s[24:27], s56 offen lds
    s_waitcnt vmcnt(3)
    s_barrier
    s_cmp_lg_u32 s42, 1
    s_cbranch_scc1 fs_f_16
    s_lshl_b32 s62, s45, 7
    s_lshl_b32 s63, s46, 2
    s_add_u32 s62, s62, s63
    s_add_u32 s62, s62, 22020096
    v_mov_b32 v162, 0
    v_mov_b32 v163, s59
    s_mov_b64 exec, 1
    buffer_store_dword v163, v162, s[16:19], s62 offen sc1
    s_mov_b64 exec, -1
fs_f_16:
    s_cmp_lg_u32 s42, 0
    s_cbranch_scc1 pc_f_17_ok
    s_waitcnt vmcnt(7)
    s_mov_b32 exec_lo, 1
    s_mov_b32 exec_hi, 0
    v_cmp_ne_u32 vcc, s59, v151
    s_mov_b64 exec, -1
    s_cmp_eq_u64 vcc, 0
    s_cbranch_scc1 pc_f_17_ok
    s_mov_b32 s51, 0
pc_f_17_chk:
    s_mov_b32 exec_lo, 1
    s_mov_b32 exec_hi, 0
    buffer_load_dword v151, v150, s[16:19], s50 offen sc1
    s_mov_b64 exec, -1
    s_waitcnt vmcnt(0)
    s_mov_b32 exec_lo, 1
    s_mov_b32 exec_hi, 0
    v_cmp_ne_u32 vcc, s59, v151
    s_mov_b64 exec, -1
    s_cmp_eq_u64 vcc, 0
    s_cbranch_scc1 pc_f_17_ok
    s_add_u32 s51, s51, 1
    s_cmp_lt_u32 s51, 32768
    s_cbranch_scc1 pc_f_17_chk
pc_f_17_ok:
    s_barrier
    s_add_u32 m0, s101, 65536
    s_add_u32 s55, s98, 3670016
    buffer_load_dwordx4 v128, s[16:19], s55 offen lds
    s_add_u32 m0, s101, 73728
    s_add_u32 s55, s98, 3932160
    buffer_load_dwordx4 v128, s[16:19], s55 offen lds
    s_add_u32 m0, s101, 81920
    s_add_u32 s55, s98, 4194304
    buffer_load_dwordx4 v128, s[16:19], s55 offen lds
    s_add_u32 m0, s101, 90112
    s_add_u32 s55, s98, 4456448
    buffer_load_dwordx4 v128, s[16:19], s55 offen lds
    s_add_u32 m0, s101, 49152
    s_add_u32 s55, s98, 4718592
    buffer_load_dwordx4 v128, s[16:19], s55 offen lds
    s_add_u32 m0, s101, 57344
    s_add_u32 s55, s98, 4980736
    buffer_load_dwordx4 v128, s[16:19], s55 offen lds
    s_add_u32 m0, s101, 32768
    s_add_u32 s55, s98, 5242880
    buffer_load_dwordx4 v128, s[16:19], s55 offen lds
    s_cmp_lg_u32 s42, 0
    s_cbranch_scc1 pi_f_18
    s_lshr_b32 s50, s92, 1
    s_lshl_b32 s50, s50, 7
    s_add_u32 s50, s50, 22020096
    s_mov_b32 exec_lo, 16383
    s_mov_b32 exec_hi, 0
    buffer_load_dword v151, v150, s[16:19], s50 offen sc1
    s_mov_b64 exec, -1
pi_f_18:
    s_waitcnt vmcnt(5)
    s_barrier
    ds_read_b128 v[32:35], v134 offset:0
    ds_read_b64_tr_b16 v[48:49], v138 offset:49152
    ds_read_b64_tr_b16 v[50:51], v138 offset:49664
    ds_read_b128 v[36:39], v135 offset:0
    ds_read_b64_tr_b16 v[52:53], v139 offset:49152
    ds_read_b64_tr_b16 v[54:55], v139 offset:49664
    s_waitcnt lgkmcnt(0)
    v_mfma_f32_32x32x16_bf16 v[64:79], v[48:51], v[32:35], 0
    ds_read_b128 v[40:43], v134 offset:8192
    ds_read_b64_tr_b16 v[56:57], v138 offset:57344
    ds_read_b64_tr_b16 v[58:59], v138 offset:57856
    v_mfma_f32_32x32x16_bf16 v[64:79], v[52:55], v[36:39], v[64:79]
    ds_read_b128 v[44:47], v135 offset:8192
    ds_read_b64_tr_b16 v[60:61], v139 offset:57344
    ds_read_b64_tr_b16 v[62:63], v139 offset:57856
    s_waitcnt vmcnt(4)
    s_barrier
    s_waitcnt lgkmcnt(0)
    v_mfma_f32_32x32x16_bf16 v[64:79], v[56:59], v[40:43], v[64:79]
    ds_read_b128 v[32:35], v134 offset:16384
    ds_read_b64_tr_b16 v[48:49], v140 offset:0
    ds_read_b64_tr_b16 v[50:51], v140 offset:512
    s_add_u32 m0, s101, 114688
    s_add_u32 s56, s99, 172032
    buffer_load_dwordx4 v129, s[24:27], s56 offen lds
    v_mfma_f32_32x32x16_bf16 v[64:79], v[60:63], v[44:47], v[64:79]
    ds_read_b128 v[36:39], v135 offset:16384
    ds_read_b64_tr_b16 v[52:53], v141 offset:0
    ds_read_b64_tr_b16 v[54:55], v141 offset:512
    s_waitcnt vmcnt(4)
    s_barrier
    s_waitcnt lgkmcnt(0)
    v_mfma_f32_32x32x16_bf16 v[64:79], v[48:51], v[32:35], v[64:79]
    ds_read_b128 v[40:43], v134 offset:24576
    ds_read_b64_tr_b16 v[56:57], v140 offset:8192
    ds_read_b64_tr_b16 v[58:59], v140 offset:8704
    s_add_u32 m0, s101, 122880
    s_add_u32 s56, s99, 229376
    buffer_load_dwordx4 v129, s[24:27], s56 offen lds
    v_mfma_f32_32x32x16_bf16 v[64:79], v[52:55], v[36:39], v[64:79]
    ds_read_b128 v[44:47], v135 offset:24576
    ds_read_b64_tr_b16 v[60:61], v141 offset:8192
    ds_read_b64_tr_b16 v[62:63], v141 offset:8704
    s_waitcnt vmcnt(4)
    s_barrier
    s_waitcnt lgkmcnt(0)
    v_mfma_f32_32x32x16_bf16 v[64:79], v[56:59], v[40:43], v[64:79]
    ds_read_b128 v[32:35], v132 offset:49152
    ds_read_b64_tr_b16 v[48:49], v138 offset:32768
    ds_read_b64_tr_b16 v[50:51], v138 offset:33280
    s_add_u32 m0, s101, 131072
    s_add_u32 s56, s99, 286720
    buffer_load_dwordx4 v129, s[24:27], s56 offen lds
    v_mfma_f32_32x32x16_bf16 v[64:79], v[60:63], v[44:47], v[64:79]
    ds_read_b128 v[36:39], v133 offset:49152
    ds_read_b64_tr_b16 v[52:53], v139 offset:32768
    ds_read_b64_tr_b16 v[54:55], v139 offset:33280
    s_waitcnt vmcnt(4)
    s_barrier
    s_waitcnt lgkmcnt(0)
    v_mfma_f32_32x32x16_bf16 v[64:79], v[48:51], v[32:35], v[64:79]
    ds_read_b128 v[40:43], v132 offset:57344
    ds_read_b64_tr_b16 v[56:57], v138 offset:40960
    ds_read_b64_tr_b16 v[58:59], v138 offset:41472
    s_add_u32 m0, s101, 139264
    s_add_u32 s56, s99, 344064
    buffer_load_dwordx4 v129, s[24:27], s56 offen lds
    v_mfma_f32_32x32x16_bf16 v[64:79], v[52:55], v[36:39], v[64:79]
    ds_read_b128 v[44:47], v133 offset:57344
    ds_read_b64_tr_b16 v[60:61], v139 offset:40960
    ds_read_b64_tr_b16 v[62:63], v139 offset:41472
    s_waitcnt vmcnt(4)
    s_barrier
    s_waitcnt lgkmcnt(0)
    v_mfma_f32_32x32x16_bf16 v[64:79], v[56:59], v[40:43], v[64:79]
    ds_read_b128 v[32:35], v132 offset:32768
    ds_read_b64_tr_b16 v[48:49], v136 offset:0
    ds_read_b64_tr_b16 v[50:51], v136 offset:512
    s_add_u32 m0, s101, 98304
    s_add_u32 s56, s99, 401408
    buffer_load_dwordx4 v129, s[24:27], s56 offen lds
    v_mfma_f32_32x32x16_bf16 v[64:79], v[60:63], v[44:47], v[64:79]
    ds_read_b128 v[36:39], v133 offset:32768
    ds_read_b64_tr_b16 v[52:53], v137 offset:0
    ds_read_b64_tr_b16 v[54:55], v137 offset:512
    s_cmp_lg_u32 s42, 0
    s_cbranch_scc1 pc_f_19_ok
    s_waitcnt vmcnt(5)
    s_mov_b32 exec_lo, 16383
    s_mov_b32 exec_hi, 0
    v_cmp_ne_u32 vcc, s59, v151
    s_mov_b64 exec, -1
    s_cmp_eq_u64 vcc, 0
    s_cbranch_scc1 pc_f_19_ok
    s_mov_b32 exec_lo, 16383
    s_mov_b32 exec_hi, 0
    buffer_load_dword v200, v150, s[16:19], s50 offen sc1
    s_mov_b64 exec, -1
    s_sleep 2
    s_mov_b32 exec_lo, 16383
    s_mov_b32 exec_hi, 0
    buffer_load_dword v201, v150, s[16:19], s50 offen sc1
    s_mov_b64 exec, -1
    s_sleep 2
    s_mov_b32 exec_lo, 16383
    s_mov_b32 exec_hi, 0
    buffer_load_dword v202, v150, s[16:19], s50 offen sc1
    s_mov_b64 exec, -1
    s_sleep 2
    s_mov_b32 s51, 0
pc_f_19_chk:
    s_mov_b32 exec_lo, 16383
    s_mov_b32 exec_hi, 0
    buffer_load_dword v151, v150, s[16:19], s50 offen sc1
    s_mov_b64 exec, -1
    s_waitcnt vmcnt(3)
    s_mov_b32 exec_lo, 16383
    s_mov_b32 exec_hi, 0
    v_cmp_ne_u32 vcc, s59, v200
    s_mov_b64 exec, -1
    s_cmp_eq_u64 vcc, 0
    s_cbranch_scc1 pc_f_19_ok
    s_mov_b32 exec_lo, 16383
    s_mov_b32 exec_hi, 0
    buffer_load_dword v200, v150, s[16:19], s50 offen sc1
    s_mov_b64 exec, -1
    s_waitcnt vmcnt(3)
    s_mov_b32 exec_lo, 16383
    s_mov_b32 exec_hi, 0
    v_cmp_ne_u32 vcc, s59, v201
    s_mov_b64 exec, -1
    s_cmp_eq_u64 vcc, 0
    s_cbranch_scc1 pc_f_19_ok
    s_mov_b32 exec_lo, 16383
    s_mov_b32 exec_hi, 0
    buffer_load_dword v201, v150, s[16:19], s50 offen sc1
    s_mov_b64 exec, -1
    s_waitcnt vmcnt(3)
    s_mov_b32 exec_lo, 16383
    s_mov_b32 exec_hi, 0
    v_cmp_ne_u32 vcc, s59, v202
    s_mov_b64 exec, -1
    s_cmp_eq_u64 vcc, 0
    s_cbranch_scc1 pc_f_19_ok
    s_mov_b32 exec_lo, 16383
    s_mov_b32 exec_hi, 0
    buffer_load_dword v202, v150, s[16:19], s50 offen sc1
    s_mov_b64 exec, -1
    s_waitcnt vmcnt(3)
    s_mov_b32 exec_lo, 16383
    s_mov_b32 exec_hi, 0
    v_cmp_ne_u32 vcc, s59, v151
    s_mov_b64 exec, -1
    s_cmp_eq_u64 vcc, 0
    s_cbranch_scc1 pc_f_19_ok
    s_add_u32 s51, s51, 1
    s_cmp_lt_u32 s51, 8192
    s_cbranch_scc1 pc_f_19_chk
pc_f_19_ok:
    s_barrier
    s_add_u32 m0, s101, 40960
    s_add_u32 s55, s98, 0
    buffer_load_dwordx4 v128, s[16:19], s55 offen lds
    s_add_u32 m0, s101, 65536
    s_add_u32 s55, s98, 262144
    buffer_load_dwordx4 v128, s[16:19], s55 offen lds
    s_add_u32 m0, s101, 73728
    s_add_u32 s55, s98, 524288
    buffer_load_dwordx4 v128, s[16:19], s55 offen lds
    s_add_u32 m0, s101, 81920
    s_add_u32 s55, s98, 786432
    buffer_load_dwordx4 v128, s[16:19], s55 offen lds
    s_add_u32 m0, s101, 90112
    s_add_u32 s55, s98, 1048576
    buffer_load_dwordx4 v128, s[16:19], s55 offen lds
    s_add_u32 m0, s101, 49152
    s_add_u32 s55, s98, 1310720
    buffer_load_dwordx4 v128, s[16:19], s55 offen lds
    s_add_u32 m0, s101, 57344
    s_add_u32 s55, s98, 1572864
    buffer_load_dwordx4 v128, s[16:19], s55 offen lds
    s_add_u32 m0, s101, 106496
    s_add_u32 s56, s99, 458752
    buffer_load_dwordx4 v129, s[24:27], s56 offen lds
    s_waitcnt lgkmcnt(0)
    v_mfma_f32_32x32x16_bf16 v[64:79], v[48:51], v[32:35], v[64:79]
    v_mfma_f32_32x32x16_bf16 v[64:79], v[52:55], v[36:39], v[64:79]
    s_waitcnt vmcnt(7)
    s_barrier
    ds_read_b128 v[40:43], v132 offset:40960
    ds_read_b64_tr_b16 v[56:57], v136 offset:8192
    ds_read_b64_tr_b16 v[58:59], v136 offset:8704
    ds_read_b128 v[44:47], v133 offset:40960
    ds_read_b64_tr_b16 v[60:61], v137 offset:8192
    ds_read_b64_tr_b16 v[62:63], v137 offset:8704
    s_waitcnt vmcnt(6)
    s_barrier
    s_waitcnt lgkmcnt(0)
    v_mfma_f32_32x32x16_bf16 v[64:79], v[56:59], v[40:43], v[64:79]
    ds_read_b128 v[32:35], v134 offset:0
    ds_read_b64_tr_b16 v[48:49], v136 offset:16384
    ds_read_b64_tr_b16 v[50:51], v136 offset:16896
    s_add_u32 m0, s101, 0
    s_add_u32 s56, s99, 516096
    buffer_load_dwordx4 v129, s[24:27], s56 offen lds
    v_mfma_f32_32x32x16_bf16 v[64:79], v[60:63], v[44:47], v[64:79]
    ds_read_b128 v[36:39], v135 offset:0
    ds_read_b64_tr_b16 v[52:53], v137 offset:16384
    ds_read_b64_tr_b16 v[54:55], v137 offset:16896
    s_add_u32 m0, s101, 32768
    s_add_u32 s55, s98, 1835008
    buffer_load_dwordx4 v128, s[16:19], s55 offen lds
    s_waitcnt vmcnt(7)
    s_barrier
    s_waitcnt lgkmcnt(0)
    v_mfma_f32_32x32x16_bf16 v[64:79], v[48:51], v[32:35], v[64:79]
    ds_read_b128 v[40:43], v134 offset:8192
    ds_read_b64_tr_b16 v[56:57], v136 offset:24576
    ds_read_b64_tr_b16 v[58:59], v136 offset:25088
    s_add_u32 m0, s101, 8192
    s_add_u32 s56, s99, 573440
    buffer_load_dwordx4 v129, s[24:27], s56 offen lds
    v_mfma_f32_32x32x16_bf16 v[64:79], v[52:55], v[36:39], v[64:79]
    ds_read_b128 v[44:47], v135 offset:8192
    ds_read_b64_tr_b16 v[60:61], v137 offset:24576
    ds_read_b64_tr_b16 v[62:63], v137 offset:25088
    s_add_u32 m0, s101, 40960
    s_add_u32 s55, s98, 2097152
    buffer_load_dwordx4 v128, s[16:19], s55 offen lds
    s_waitcnt vmcnt(8)
    s_barrier
    s_waitcnt lgkmcnt(0)
    v_mfma_f32_32x32x16_bf16 v[64:79], v[56:59], v[40:43], v[64:79]
    ds_read_b128 v[32:35], v134 offset:16384
    ds_read_b64_tr_b16 v[48:49], v138 offset:49152
    ds_read_b64_tr_b16 v[50:51], v138 offset:49664
    s_add_u32 m0, s101, 16384
    s_add_u32 s56, s99, 630784
    buffer_load_dwordx4 v129, s[24:27], s56 offen lds
    v_mfma_f32_32x32x16_bf16 v[64:79], v[60:63], v[44:47], v[64:79]
    ds_read_b128 v[36:39], v135 offset:16384
    ds_read_b64_tr_b16 v[52:53], v139 offset:49152
    ds_read_b64_tr_b16 v[54:55], v139 offset:49664
    s_add_u32 m0, s101, 65536
    s_add_u32 s55, s98, 2359296
    buffer_load_dwordx4 v128, s[16:19], s55 offen lds
    s_waitcnt vmcnt(9)
    s_barrier
    s_waitcnt lgkmcnt(0)
    v_mfma_f32_32x32x16_bf16 v[64:79], v[48:51], v[32:35], v[64:79]
    ds_read_b128 v[40:43], v134 offset:24576
    ds_read_b64_tr_b16 v[56:57], v138 offset:57344
    ds_read_b64_tr_b16 v[58:59], v138 offset:57856
    s_add_u32 m0, s101, 24576
    s_add_u32 s56, s99, 688128
    buffer_load_dwordx4 v129, s[24:27], s56 offen lds
    v_mfma_f32_32x32x16_bf16 v[64:79], v[52:55], v[36:39], v[64:79]
    ds_read_b128 v[44:47], v135 offset:24576
    ds_read_b64_tr_b16 v[60:61], v139 offset:57344
    ds_read_b64_tr_b16 v[62:63], v139 offset:57856
    s_add_u32 m0, s101, 73728
    s_add_u32 s55, s98, 2621440
    buffer_load_dwordx4 v128, s[16:19], s55 offen lds
    s_waitcnt vmcnt(10)
    s_barrier
    s_waitcnt lgkmcnt(0)
    v_mfma_f32_32x32x16_bf16 v[64:79], v[56:59], v[40:43], v[64:79]
    ds_read_b128 v[32:35], v132 offset:49152
    ds_read_b64_tr_b16 v[48:49], v140 offset:0
    ds_read_b64_tr_b16 v[50:51], v140 offset:512
    s_add_u32 m0, s101, 114688
    s_add_u32 s56, s99, 745472
    buffer_load_dwordx4 v129, s[24:27], s56 offen lds
    v_mfma_f32_32x32x16_bf16 v[64:79], v[60:63], v[44:47], v[64:79]
    ds_read_b128 v[36:39], v133 offset:49152
    ds_read_b64_tr_b16 v[52:53], v141 offset:0
    ds_read_b64_tr_b16 v[54:55], v141 offset:512
    s_add_u32 m0, s101, 81920
    s_add_u32 s55, s98, 2883584
    buffer_load_dwordx4 v128, s[16:19], s55 offen lds
    s_waitcnt vmcnt(11)
    s_barrier
    s_waitcnt lgkmcnt(0)
    v_mfma_f32_32x32x16_bf16 v[64:79], v[48:51], v[32:35], v[64:79]
    ds_read_b128 v[40:43], v132 offset:57344
    ds_read_b64_tr_b16 v[56:57], v140 offset:8192
    ds_read_b64_tr_b16 v[58:59], v140 offset:8704
    s_add_u32 m0, s101, 90112
    s_add_u32 s55, s98, 3145728
    buffer_load_dwordx4 v128, s[16:19], s55 offen lds
    v_mfma_f32_32x32x16_bf16 v[64:79], v[52:55], v[36:39], v[64:79]
    ds_read_b128 v[44:47], v133 offset:57344
    ds_read_b64_tr_b16 v[60:61], v141 offset:8192
    ds_read_b64_tr_b16 v[62:63], v141 offset:8704
    s_waitcnt vmcnt(9)
    s_barrier
    s_waitcnt lgkmcnt(0)
    v_mfma_f32_32x32x16_bf16 v[64:79], v[56:59], v[40:43], v[64:79]
    ds_read_b128 v[32:35], v132 offset:32768
    ds_read_b64_tr_b16 v[48:49], v138 offset:32768
    ds_read_b64_tr_b16 v[50:51], v138 offset:33280
    s_add_u32 m0, s101, 49152
    s_add_u32 s55, s98, 3407872
    buffer_load_dwordx4 v128, s[16:19], s55 offen lds
    v_mfma_f32_32x32x16_bf16 v[64:79], v[60:63], v[44:47], v[64:79]
    ds_read_b128 v[36:39], v133 offset:32768
    ds_read_b64_tr_b16 v[52:53], v139 offset:32768
    ds_read_b64_tr_b16 v[54:55], v139 offset:33280
    s_waitcnt vmcnt(8)
    s_barrier
    s_waitcnt lgkmcnt(0)
    v_mfma_f32_32x32x16_bf16 v[64:79], v[48:51], v[32:35], v[64:79]
    ds_read_b128 v[40:43], v132 offset:40960
    ds_read_b64_tr_b16 v[56:57], v138 offset:40960
    ds_read_b64_tr_b16 v[58:59], v138 offset:41472
    v_mfma_f32_32x32x16_bf16 v[64:79], v[52:55], v[36:39], v[64:79]
    ds_read_b128 v[44:47], v133 offset:40960
    ds_read_b64_tr_b16 v[60:61], v139 offset:40960
    ds_read_b64_tr_b16 v[62:63], v139 offset:41472
    s_waitcnt vmcnt(6)
    s_barrier
    s_waitcnt lgkmcnt(0)
    v_mfma_f32_32x32x16_bf16 v[64:79], v[56:59], v[40:43], v[64:79]
    ds_read_b128 v[32:35], v134 offset:0
    ds_read_b64_tr_b16 v[48:49], v136 offset:0
    ds_read_b64_tr_b16 v[50:51], v136 offset:512
    v_mfma_f32_32x32x16_bf16 v[64:79], v[60:63], v[44:47], v[64:79]
    ds_read_b128 v[36:39], v135 offset:0
    ds_read_b64_tr_b16 v[52:53], v137 offset:0
    ds_read_b64_tr_b16 v[54:55], v137 offset:512
    s_waitcnt vmcnt(4)
    s_barrier
    s_waitcnt lgkmcnt(0)
    v_mfma_f32_32x32x16_bf16 v[64:79], v[48:51], v[32:35], v[64:79]
    ds_read_b128 v[40:43], v134 offset:8192
    ds_read_b64_tr_b16 v[56:57], v136 offset:8192
    ds_read_b64_tr_b16 v[58:59], v136 offset:8704
    v_mfma_f32_32x32x16_bf16 v[64:79], v[52:55], v[36:39], v[64:79]
    ds_read_b128 v[44:47], v135 offset:8192
    ds_read_b64_tr_b16 v[60:61], v137 offset:8192
    ds_read_b64_tr_b16 v[62:63], v137 offset:8704
    s_waitcnt vmcnt(2)
    s_barrier
    s_waitcnt lgkmcnt(0)
    v_mfma_f32_32x32x16_bf16 v[64:79], v[56:59], v[40:43], v[64:79]
    ds_read_b128 v[32:35], v134 offset:16384
    ds_read_b64_tr_b16 v[48:49], v136 offset:16384
    ds_read_b64_tr_b16 v[50:51], v136 offset:16896
    v_mfma_f32_32x32x16_bf16 v[64:79], v[60:63], v[44:47], v[64:79]
    ds_read_b128 v[36:39], v135 offset:16384
    ds_read_b64_tr_b16 v[52:53], v137 offset:16384
    ds_read_b64_tr_b16 v[54:55], v137 offset:16896
    s_waitcnt vmcnt(1)
    s_barrier
    s_waitcnt lgkmcnt(0)
    v_mfma_f32_32x32x16_bf16 v[64:79], v[48:51], v[32:35], v[64:79]
    ds_read_b128 v[40:43], v134 offset:24576
    ds_read_b64_tr_b16 v[56:57], v136 offset:24576
    ds_read_b64_tr_b16 v[58:59], v136 offset:25088
    v_mfma_f32_32x32x16_bf16 v[64:79], v[52:55], v[36:39], v[64:79]
    ds_read_b128 v[44:47], v135 offset:24576
    ds_read_b64_tr_b16 v[60:61], v137 offset:24576
    ds_read_b64_tr_b16 v[62:63], v137 offset:25088
    s_waitcnt vmcnt(0)
    s_barrier
    s_waitcnt lgkmcnt(0)
    v_mfma_f32_32x32x16_bf16 v[64:79], v[56:59], v[40:43], v[64:79]
    ds_read_b128 v[32:35], v132 offset:49152
    ds_read_b64_tr_b16 v[48:49], v138 offset:49152
    ds_read_b64_tr_b16 v[50:51], v138 offset:49664
    v_mfma_f32_32x32x16_bf16 v[64:79], v[60:63], v[44:47], v[64:79]
    ds_read_b128 v[36:39], v133 offset:49152
    ds_read_b64_tr_b16 v[52:53], v139 offset:49152
    ds_read_b64_tr_b16 v[54:55], v139 offset:49664
    s_waitcnt lgkmcnt(0)
    v_mfma_f32_32x32x16_bf16 v[64:79], v[48:51], v[32:35], v[64:79]
    v_mfma_f32_32x32x16_bf16 v[64:79], v[52:55], v[36:39], v[64:79]
    s_barrier
    s_cmp_lg_u32 s94, 0
    s_cbranch_scc1 k3a_f_20
    s_nop 8
    ds_write_b128 v143, v[72:75] offset:0
    ds_write_b128 v143, v[76:79] offset:1024
    s_branch k3b_f_21
k3a_f_20:
    ds_write_b128 v143, v[64:67] offset:0
    ds_write_b128 v143, v[68:71] offset:1024
    v_mov_b32 v64, v72
    v_mov_b32 v65, v73
    v_mov_b32 v66, v74
    v_mov_b32 v67, v75
    v_mov_b32 v68, v76
    v_mov_b32 v69, v77
    v_mov_b32 v70, v78
    v_mov_b32 v71, v79
k3b_f_21:
    ds_read_b64 v[32:33], v144
    ds_read_b64 v[34:35], v145
    s_waitcnt lgkmcnt(0)
    s_barrier
    ds_read_b128 v[48:51], v142 offset:0
    ds_read_b128 v[52:55], v142 offset:1024
    v_lshlrev_b32 v152, 16, v32
    v_and_b32 v153, 0xffff0000, v32
    v_lshlrev_b32 v154, 16, v33
    v_and_b32 v155, 0xffff0000, v33
    v_lshlrev_b32 v156, 16, v34
    v_and_b32 v157, 0xffff0000, v34
    v_lshlrev_b32 v158, 16, v35
    v_and_b32 v159, 0xffff0000, v35
    v_add_f32 v64, v64, v152
    v_add_f32 v65, v65, v153
    v_add_f32 v66, v66, v154
    v_add_f32 v67, v67, v155
    v_add_f32 v68, v68, v156
    v_add_f32 v69, v69, v157
    v_add_f32 v70, v70, v158
    v_add_f32 v71, v71, v159
    s_waitcnt lgkmcnt(0)
    v_add_f32 v64, v64, v48
    v_add_f32 v65, v65, v49
    v_add_f32 v66, v66, v50
    v_add_f32 v67, v67, v51
    v_add_f32 v68, v68, v52
    v_add_f32 v69, v69, v53
    v_add_f32 v70, v70, v54
    v_add_f32 v71, v71, v55
    v_cvt_pk_bf16_f32 v152, v64, v65
    v_cvt_pk_bf16_f32 v153, v66, v67
    v_cvt_pk_bf16_f32 v154, v68, v69
    v_cvt_pk_bf16_f32 v155, v70, v71
    ds_write_b64 v146, v[152:153] offset:16384
    ds_write_b64 v146, v[154:155] offset:16400
    s_mul_i32 s55, s97, 896
    s_lshl_b32 s56, s93, 7
    s_add_u32 s55, s55, s56
    s_waitcnt lgkmcnt(0)
    s_barrier
    ds_read_b128 v[32:35], v147 offset:16384
    s_waitcnt lgkmcnt(0)
    buffer_store_dwordx4 v[32:35], v148, s[32:35], s55 offen
    s_branch L_fin_f
L_aux:
    s_sub_u32 s48, s2, 224
    s_and_b32 s49, s48, 1
    s_lshr_b32 s50, s48, 3
    s_lshl_b32 s50, s50, 9
    v_add_u32 v2, s50, v0
    s_waitcnt lgkmcnt(0)
    s_mov_b32 s10, 1605632
    s_mov_b32 s11, 0x20000
    s_mov_b32 s14, 1204224
    s_mov_b32 s15, 0x20000
    s_mul_i32 s51, s49, 896
    s_add_u32 s51, s51, 689920
    v_add_u32 v3, 0, v2
    v_min_u32 v3, 1791, v3
    v_mul_u32_u24 v4, 9363, v3
    v_lshrrev_b32 v4, 16, v4
    v_mul_u32_u24 v5, 7, v4
    v_sub_u32 v3, v3, v5
    v_mul_u32_u24 v4, 3584, v4
    v_lshl_add_u32 v3, v3, 7, v4
    buffer_load_dword v16, v3, s[8:11], s51 offen
    s_mul_i32 s51, s49, 1280
    s_add_u32 s51, s51, 0
    v_add_u32 v3, 0, v2
    v_min_u32 v3, 4927, v3
    v_mul_u32_u24 v4, 5958, v3
    v_lshrrev_b32 v4, 16, v4
    v_mul_u32_u24 v5, 11, v4
    v_sub_u32 v3, v3, v5
    v_mul_u32_u24 v4, 2688, v4
    v_lshl_add_u32 v3, v3, 7, v4
    buffer_load_dword v17, v3, s[12:15], s51 offen
    v_add_u32 v3, 2048, v2
    v_min_u32 v3, 4927, v3
    v_mul_u32_u24 v4, 5958, v3
    v_lshrrev_b32 v4, 16, v4
    v_mul_u32_u24 v5, 11, v4
    v_sub_u32 v3, v3, v5
    v_mul_u32_u24 v4, 2688, v4
    v_lshl_add_u32 v3, v3, 7, v4
    buffer_load_dword v18, v3, s[12:15], s51 offen
    v_add_u32 v3, 4096, v2
    v_min_u32 v3, 4927, v3
    v_mul_u32_u24 v4, 5958, v3
    v_lshrrev_b32 v4, 16, v4
    v_mul_u32_u24 v5, 11, v4
    v_sub_u32 v3, v3, v5
    v_mul_u32_u24 v4, 2688, v4
    v_lshl_add_u32 v3, v3, 7, v4
    buffer_load_dword v19, v3, s[12:15], s51 offen
    s_load_dwordx2 s[20:21], s[0:1], 40
    s_load_dwordx2 s[24:25], s[0:1], 56
    s_load_dwordx2 s[28:29], s[0:1], 16
    s_sub_u32 s48, s2, 224
    s_waitcnt lgkmcnt(0)
    s_mov_b32 s22, 8388608
    s_mov_b32 s23, 0x20000
    s_mov_b32 s26, 802816
    s_mov_b32 s27, 0x20000
    s_mov_b32 s30, 401408
    s_mov_b32 s31, 0x20000
    s_getpc_b64 s[52:53]
L_hp:
    s_sub_u32 s52, s52, L_hp-L_k2
    s_subb_u32 s53, s53, 0
    s_mov_b32 s54, L_end-L_k2-16
    s_sub_u32 s55, s2, 224
    s_lshr_b32 s55, s55, 3
    s_lshl_b32 s55, s55, 13
    v_lshlrev_b32 v3, 4, v0
    v_add_u32 v3, s55, v3
L_hp_loop:
    v_cmp_ge_u32 vcc, s54, v3
    s_and_b64 exec, exec, vcc
    s_cbranch_execz L_hp_done
    global_load_dwordx4 v[28:31], v3, s[52:53]
    v_add_u32 v3, 32768, v3
    s_branch L_hp_loop
L_hp_done:
    s_mov_b64 exec, -1
    s_mul_i32 s49, s42, 32
    v_add_u32 v2, s49, v1
    v_lshlrev_b32 v2, 7, v2
    s_sub_u32 s49, s2, 224
    s_lshl_b32 s49, s49, 18
    s_waitcnt vmcnt(0)
    s_mov_b32 exec_hi, 0
    buffer_load_dword v8, v2, s[20:23], s49 offen
    s_add_u32 s49, s49, 32768
    s_waitcnt vmcnt(1)
    buffer_load_dword v9, v2, s[20:23], s49 offen
    s_add_u32 s49, s49, 32768
    s_waitcnt vmcnt(1)
    buffer_load_dword v10, v2, s[20:23], s49 offen
    s_add_u32 s49, s49, 32768
    s_waitcnt vmcnt(1)
    buffer_load_dword v11, v2, s[20:23], s49 offen
    s_add_u32 s49, s49, 32768
    s_waitcnt vmcnt(1)
    buffer_load_dword v12, v2, s[20:23], s49 offen
    s_add_u32 s49, s49, 32768
    s_waitcnt vmcnt(1)
    buffer_load_dword v13, v2, s[20:23], s49 offen
    s_add_u32 s49, s49, 32768
    s_waitcnt vmcnt(1)
    buffer_load_dword v14, v2, s[20:23], s49 offen
    s_add_u32 s49, s49, 32768
    s_waitcnt vmcnt(1)
    buffer_load_dword v15, v2, s[20:23], s49 offen
    s_mov_b64 exec, -1
    v_lshlrev_b32 v2, 7, v0
    s_mul_i32 s49, s48, 25088
    v_cmp_gt_u32 vcc, 25088, v2
    s_and_b64 exec, exec, vcc
    buffer_load_dword v24, v2, s[24:27], s49 offen
    s_mul_i32 s49, s48, 12544
    v_cmp_gt_u32 vcc, 12544, v2
    s_and_b64 exec, exec, vcc
    buffer_load_dword v25, v2, s[28:31], s49 offen
    s_mov_b64 exec, -1
    v_mov_b32 v2, 0
    s_mov_b32 s51, 0
L_anon:
    global_load_dword v3, v2, s[40:41] sc1
    s_waitcnt vmcnt(0)
    v_readfirstlane_b32 s59, v3
    s_cmp_lg_u32 s59, 0
    s_cbranch_scc1 L_anon_ok
    s_add_u32 s51, s51, 1
    s_cmp_lt_u32 s51, 0x40000
    s_cbranch_scc1 L_anon
L_anon_ok:
    s_mov_b32 s18, 268435456
    s_mov_b32 s19, 0x20000
    s_sub_u32 s48, s2, 224
    s_lshr_b32 s49, s48, 1
    s_lshl_b32 s48, s48, 6
    s_sub_i32 s48, s48, 14
    s_max_i32 s48, s48, 0
    s_lshr_b32 s48, s48, 7
    s_lshl_b32 s48, s48, 7
    s_lshl_b32 s49, s49, 7
    v_and_b32 v4, 15, v1
    v_lshlrev_b32 v4, 2, v4
    v_mov_b32 v8, s48
    v_mov_b32 v9, s49
    v_cmp_gt_u32 vcc, 16, v1
    s_nop 1
    v_cndmask_b32 v8, v8, v9, vcc
    v_add_u32 v4, v4, v8
    s_cmp_lg_u32 s42, 0
    s_cbranch_scc1 pi_f_22
    s_mov_b32 s50, 22032384
    s_mov_b32 exec_lo, 1073692671
    s_mov_b32 exec_hi, 0
    buffer_load_dword v5, v4, s[16:19], s50 offen sc1
    s_mov_b64 exec, -1
pi_f_22:
    s_cmp_lg_u32 s42, 0
    s_cbranch_scc1 pc_f_23_ok
    s_waitcnt vmcnt(0)
    s_mov_b32 exec_lo, 1073692671
    s_mov_b32 exec_hi, 0
    v_cmp_ne_u32 vcc, s59, v5
    s_mov_b64 exec, -1
    s_cmp_eq_u64 vcc, 0
    s_cbranch_scc1 pc_f_23_ok
    s_mov_b32 exec_lo, 1073692671
    s_mov_b32 exec_hi, 0
    buffer_load_dword v6, v4, s[16:19], s50 offen sc1
    s_mov_b64 exec, -1
    s_sleep 2
    s_mov_b32 s51, 0
pc_f_23_chk:
    s_sleep 2
    s_mov_b32 exec_lo, 1073692671
    s_mov_b32 exec_hi, 0
    buffer_load_dword v5, v4, s[16:19], s50 offen sc1
    s_mov_b64 exec, -1
    s_waitcnt vmcnt(1)
    s_mov_b32 exec_lo, 1073692671
    s_mov_b32 exec_hi, 0
    v_cmp_ne_u32 vcc, s59, v6
    s_mov_b64 exec, -1
    s_cmp_eq_u64 vcc, 0
    s_cbranch_scc1 pc_f_23_ok
    s_sleep 2
    s_mov_b32 exec_lo, 1073692671
    s_mov_b32 exec_hi, 0
    buffer_load_dword v6, v4, s[16:19], s50 offen sc1
    s_mov_b64 exec, -1
    s_waitcnt vmcnt(1)
    s_mov_b32 exec_lo, 1073692671
    s_mov_b32 exec_hi, 0
    v_cmp_ne_u32 vcc, s59, v5
    s_mov_b64 exec, -1
    s_cmp_eq_u64 vcc, 0
    s_cbranch_scc1 pc_f_23_ok
    s_add_u32 s51, s51, 1
    s_cmp_lt_u32 s51, 65536
    s_cbranch_scc1 pc_f_23_chk
pc_f_23_ok:
    s_barrier
    s_sub_u32 s48, s2, 224
    s_lshl_b32 s49, s48, 6
    v_and_b32 v246, 15, v1
    v_mul_u32_u24 v246, 56, v246
    v_lshrrev_b32 v247, 4, v1
    v_and_b32 v245, 1, v247
    v_lshrrev_b32 v247, 1, v247
    v_lshl_add_u32 v245, v247, 2, v245
    s_lshl_b32 s50, s42, 3
    v_add_u32 v245, s50, v245
    v_mul_u32_u24 v243, 2688, v245
    v_add_u32 v243, v243, v246
    v_mul_u32_u24 v242, 1920, v245
    v_add_u32 v242, v242, v246
    v_lshlrev_b32 v244, 4, v1
    s_mul_i32 s52, s49, 2688
    s_add_u32 s52, s52, 8388608
    s_add_u32 s53, s52, 5376
    s_waitcnt lgkmcnt(0)
    s_mov_b32 s18, 268435456
    s_mov_b32 s19, 0x20000
    s_mov_b32 exec_hi, 0x00ffffff
    s_add_u32 s50, s42, 0
    s_min_u32 s50, s50, 77
    s_mul_i32 s51, s50, 1920
    s_add_u32 m0, s51, 0
    s_add_u32 s50, s50, s49
    s_sub_i32 s50, s50, 14
    s_max_i32 s50, s50, 0
    s_mul_i32 s50, s50, 2688
    s_add_u32 s50, s50, 8389504
    buffer_load_dwordx4 v244, s[16:19], s50 offen lds
    s_add_u32 s50, s42, 8
    s_min_u32 s50, s50, 77
    s_mul_i32 s51, s50, 1920
    s_add_u32 m0, s51, 0
    s_add_u32 s50, s50, s49
    s_sub_i32 s50, s50, 14
    s_max_i32 s50, s50, 0
    s_mul_i32 s50, s50, 2688
    s_add_u32 s50, s50, 8389504
    buffer_load_dwordx4 v244, s[16:19], s50 offen lds
    s_add_u32 s50, s42, 16
    s_min_u32 s50, s50, 77
    s_mul_i32 s51, s50, 1920
    s_add_u32 m0, s51, 0
    s_add_u32 s50, s50, s49
    s_sub_i32 s50, s50, 14
    s_max_i32 s50, s50, 0
    s_mul_i32 s50, s50, 2688
    s_add_u32 s50, s50, 8389504
    buffer_load_dwordx4 v244, s[16:19], s50 offen lds
    s_add_u32 s50, s42, 24
    s_min_u32 s50, s50, 77
    s_mul_i32 s51, s50, 1920
    s_add_u32 m0, s51, 0
    s_add_u32 s50, s50, s49
    s_sub_i32 s50, s50, 14
    s_max_i32 s50, s50, 0
    s_mul_i32 s50, s50, 2688
    s_add_u32 s50, s50, 8389504
    buffer_load_dwordx4 v244, s[16:19], s50 offen lds
    s_add_u32 s50, s42, 32
    s_min_u32 s50, s50, 77
    s_mul_i32 s51, s50, 1920
    s_add_u32 m0, s51, 0
    s_add_u32 s50, s50, s49
    s_sub_i32 s50, s50, 14
    s_max_i32 s50, s50, 0
    s_mul_i32 s50, s50, 2688
    s_add_u32 s50, s50, 8389504
    buffer_load_dwordx4 v244, s[16:19], s50 offen lds
    s_add_u32 s50, s42, 40
    s_min_u32 s50, s50, 77
    s_mul_i32 s51, s50, 1920
    s_add_u32 m0, s51, 0
    s_add_u32 s50, s50, s49
    s_sub_i32 s50, s50, 14
    s_max_i32 s50, s50, 0
    s_mul_i32 s50, s50, 2688
    s_add_u32 s50, s50, 8389504
    buffer_load_dwordx4 v244, s[16:19], s50 offen lds
    s_add_u32 s50, s42, 48
    s_min_u32 s50, s50, 77
    s_mul_i32 s51, s50, 1920
    s_add_u32 m0, s51, 0
    s_add_u32 s50, s50, s49
    s_sub_i32 s50, s50, 14
    s_max_i32 s50, s50, 0
    s_mul_i32 s50, s50, 2688
    s_add_u32 s50, s50, 8389504
    buffer_load_dwordx4 v244, s[16:19], s50 offen lds
    s_add_u32 s50, s42, 56
    s_min_u32 s50, s50, 77
    s_mul_i32 s51, s50, 1920
    s_add_u32 m0, s51, 0
    s_add_u32 s50, s50, s49
    s_sub_i32 s50, s50, 14
    s_max_i32 s50, s50, 0
    s_mul_i32 s50, s50, 2688
    s_add_u32 s50, s50, 8389504
    buffer_load_dwordx4 v244, s[16:19], s50 offen lds
    s_add_u32 s50, s42, 64
    s_min_u32 s50, s50, 77
    s_mul_i32 s51, s50, 1920
    s_add_u32 m0, s51, 0
    s_add_u32 s50, s50, s49
    s_sub_i32 s50, s50, 14
    s_max_i32 s50, s50, 0
    s_mul_i32 s50, s50, 2688
    s_add_u32 s50, s50, 8389504
    buffer_load_dwordx4 v244, s[16:19], s50 offen lds
    s_add_u32 s50, s42, 72
    s_min_u32 s50, s50, 77
    s_mul_i32 s51, s50, 1920
    s_add_u32 m0, s51, 0
    s_add_u32 s50, s50, s49
    s_sub_i32 s50, s50, 14
    s_max_i32 s50, s50, 0
    s_mul_i32 s50, s50, 2688
    s_add_u32 s50, s50, 8389504
    buffer_load_dwordx4 v244, s[16:19], s50 offen lds
    s_mov_b32 exec_hi, -1
    buffer_load_dwordx4 v[8:11], v243, s[16:19], s52 offen offset:0
    buffer_load_dwordx4 v[12:15], v243, s[16:19], s52 offen offset:16
    buffer_load_dwordx4 v[16:19], v243, s[16:19], s52 offen offset:32
    buffer_load_dwordx2 v[20:21], v243, s[16:19], s52 offen offset:48
    buffer_load_dwordx4 v[22:25], v243, s[16:19], s53 offen offset:0
    buffer_load_dwordx4 v[26:29], v243, s[16:19], s53 offen offset:16
    buffer_load_dwordx4 v[30:33], v243, s[16:19], s53 offen offset:32
    buffer_load_dwordx2 v[34:35], v243, s[16:19], s53 offen offset:48
    s_mov_b32 exec_hi, 0x00ffffff
    s_add_u32 s50, s42, 0
    s_min_u32 s50, s50, 77
    s_mul_i32 s51, s50, 1920
    s_add_u32 m0, s51, 896
    s_add_u32 s50, s50, s49
    s_sub_i32 s50, s50, 14
    s_max_i32 s50, s50, 0
    s_mul_i32 s50, s50, 2688
    s_add_u32 s50, s50, 8390400
    buffer_load_dwordx4 v244, s[16:19], s50 offen lds
    s_add_u32 s50, s42, 8
    s_min_u32 s50, s50, 77
    s_mul_i32 s51, s50, 1920
    s_add_u32 m0, s51, 896
    s_add_u32 s50, s50, s49
    s_sub_i32 s50, s50, 14
    s_max_i32 s50, s50, 0
    s_mul_i32 s50, s50, 2688
    s_add_u32 s50, s50, 8390400
    buffer_load_dwordx4 v244, s[16:19], s50 offen lds
    s_add_u32 s50, s42, 16
    s_min_u32 s50, s50, 77
    s_mul_i32 s51, s50, 1920
    s_add_u32 m0, s51, 896
    s_add_u32 s50, s50, s49
    s_sub_i32 s50, s50, 14
    s_max_i32 s50, s50, 0
    s_mul_i32 s50, s50, 2688
    s_add_u32 s50, s50, 8390400
    buffer_load_dwordx4 v244, s[16:19], s50 offen lds
    s_add_u32 s50, s42, 24
    s_min_u32 s50, s50, 77
    s_mul_i32 s51, s50, 1920
    s_add_u32 m0, s51, 896
    s_add_u32 s50, s50, s49
    s_sub_i32 s50, s50, 14
    s_max_i32 s50, s50, 0
    s_mul_i32 s50, s50, 2688
    s_add_u32 s50, s50, 8390400
    buffer_load_dwordx4 v244, s[16:19], s50 offen lds
    s_add_u32 s50, s42, 32
    s_min_u32 s50, s50, 77
    s_mul_i32 s51, s50, 1920
    s_add_u32 m0, s51, 896
    s_add_u32 s50, s50, s49
    s_sub_i32 s50, s50, 14
    s_max_i32 s50, s50, 0
    s_mul_i32 s50, s50, 2688
    s_add_u32 s50, s50, 8390400
    buffer_load_dwordx4 v244, s[16:19], s50 offen lds
    s_add_u32 s50, s42, 40
    s_min_u32 s50, s50, 77
    s_mul_i32 s51, s50, 1920
    s_add_u32 m0, s51, 896
    s_add_u32 s50, s50, s49
    s_sub_i32 s50, s50, 14
    s_max_i32 s50, s50, 0
    s_mul_i32 s50, s50, 2688
    s_add_u32 s50, s50, 8390400
    buffer_load_dwordx4 v244, s[16:19], s50 offen lds
    s_add_u32 s50, s42, 48
    s_min_u32 s50, s50, 77
    s_mul_i32 s51, s50, 1920
    s_add_u32 m0, s51, 896
    s_add_u32 s50, s50, s49
    s_sub_i32 s50, s50, 14
    s_max_i32 s50, s50, 0
    s_mul_i32 s50, s50, 2688
    s_add_u32 s50, s50, 8390400
    buffer_load_dwordx4 v244, s[16:19], s50 offen lds
    s_add_u32 s50, s42, 56
    s_min_u32 s50, s50, 77
    s_mul_i32 s51, s50, 1920
    s_add_u32 m0, s51, 896
    s_add_u32 s50, s50, s49
    s_sub_i32 s50, s50, 14
    s_max_i32 s50, s50, 0
    s_mul_i32 s50, s50, 2688
    s_add_u32 s50, s50, 8390400
    buffer_load_dwordx4 v244, s[16:19], s50 offen lds
    s_add_u32 s50, s42, 64
    s_min_u32 s50, s50, 77
    s_mul_i32 s51, s50, 1920
    s_add_u32 m0, s51, 896
    s_add_u32 s50, s50, s49
    s_sub_i32 s50, s50, 14
    s_max_i32 s50, s50, 0
    s_mul_i32 s50, s50, 2688
    s_add_u32 s50, s50, 8390400
    buffer_load_dwordx4 v244, s[16:19], s50 offen lds
    s_add_u32 s50, s42, 72
    s_min_u32 s50, s50, 77
    s_mul_i32 s51, s50, 1920
    s_add_u32 m0, s51, 896
    s_add_u32 s50, s50, s49
    s_sub_i32 s50, s50, 14
    s_max_i32 s50, s50, 0
    s_mul_i32 s50, s50, 2688
    s_add_u32 s50, s50, 8390400
    buffer_load_dwordx4 v244, s[16:19], s50 offen lds
    s_mov_b32 exec_hi, -1
    s_waitcnt vmcnt(10)
    s_barrier
    ds_read_b64 v[36:37], v242 offset:30720
    ds_read_b64 v[38:39], v242 offset:30728
    ds_read_b64 v[40:41], v242 offset:30736
    ds_read_b64 v[42:43], v242 offset:30744
    ds_read_b64 v[44:45], v242 offset:30752
    ds_read_b64 v[46:47], v242 offset:30760
    ds_read_b64 v[48:49], v242 offset:30768
    ds_read_b64 v[50:51], v242 offset:26880
    ds_read_b64 v[52:53], v242 offset:26888
    ds_read_b64 v[54:55], v242 offset:26896
    ds_read_b64 v[56:57], v242 offset:26904
    ds_read_b64 v[58:59], v242 offset:26912
    ds_read_b64 v[60:61], v242 offset:26920
    ds_read_b64 v[62:63], v242 offset:26928
    ds_read_b64 v[64:65], v242 offset:23040
    ds_read_b64 v[66:67], v242 offset:23048
    ds_read_b64 v[68:69], v242 offset:23056
    ds_read_b64 v[70:71], v242 offset:23064
    ds_read_b64 v[72:73], v242 offset:23072
    ds_read_b64 v[74:75], v242 offset:23080
    ds_read_b64 v[76:77], v242 offset:23088
    ds_read_b64 v[78:79], v242 offset:19200
    ds_read_b64 v[80:81], v242 offset:19208
    ds_read_b64 v[82:83], v242 offset:19216
    ds_read_b64 v[84:85], v242 offset:19224
    ds_read_b64 v[86:87], v242 offset:19232
    ds_read_b64 v[88:89], v242 offset:19240
    ds_read_b64 v[90:91], v242 offset:19248
    ds_read_b64 v[92:93], v242 offset:15360
    ds_read_b64 v[94:95], v242 offset:15368
    ds_read_b64 v[96:97], v242 offset:15376
    ds_read_b64 v[98:99], v242 offset:15384
    ds_read_b64 v[100:101], v242 offset:15392
    ds_read_b64 v[102:103], v242 offset:15400
    ds_read_b64 v[104:105], v242 offset:15408
    ds_read_b64 v[106:107], v242 offset:11520
    ds_read_b64 v[108:109], v242 offset:11528
    ds_read_b64 v[110:111], v242 offset:11536
    ds_read_b64 v[112:113], v242 offset:11544
    ds_read_b64 v[114:115], v242 offset:11552
    ds_read_b64 v[116:117], v242 offset:11560
    ds_read_b64 v[118:119], v242 offset:11568
    ds_read_b64 v[120:121], v242 offset:7680
    ds_read_b64 v[122:123], v242 offset:7688
    ds_read_b64 v[124:125], v242 offset:7696
    ds_read_b64 v[126:127], v242 offset:7704
    ds_read_b64 v[128:129], v242 offset:7712
    ds_read_b64 v[130:131], v242 offset:7720
    ds_read_b64 v[132:133], v242 offset:7728
    ds_read_b64 v[134:135], v242 offset:3840
    ds_read_b64 v[136:137], v242 offset:3848
    ds_read_b64 v[138:139], v242 offset:3856
    ds_read_b64 v[140:141], v242 offset:3864
    ds_read_b64 v[142:143], v242 offset:3872
    ds_read_b64 v[144:145], v242 offset:3880
    ds_read_b64 v[146:147], v242 offset:3888
    ds_read_b64 v[148:149], v242 offset:0
    ds_read_b64 v[150:151], v242 offset:8
    ds_read_b64 v[152:153], v242 offset:16
    ds_read_b64 v[154:155], v242 offset:24
    ds_read_b64 v[156:157], v242 offset:32
    ds_read_b64 v[158:159], v242 offset:40
    ds_read_b64 v[160:161], v242 offset:48
    s_waitcnt lgkmcnt(15)
    v_dot2_f32_bf16 v170, v22, v36, 0
    v_dot2_f32_bf16 v171, v22, v50, 0
    v_dot2_f32_bf16 v162, v8, v50, 0
    v_dot2_f32_bf16 v170, v23, v37, v170
    v_dot2_f32_bf16 v171, v23, v51, v171
    v_dot2_f32_bf16 v162, v9, v51, v162
    v_dot2_f32_bf16 v170, v24, v38, v170
    v_dot2_f32_bf16 v171, v24, v52, v171
    v_dot2_f32_bf16 v162, v10, v52, v162
    v_dot2_f32_bf16 v170, v25, v39, v170
    v_dot2_f32_bf16 v171, v25, v53, v171
    v_dot2_f32_bf16 v162, v11, v53, v162
    v_dot2_f32_bf16 v170, v26, v40, v170
    v_dot2_f32_bf16 v171, v26, v54, v171
    v_dot2_f32_bf16 v162, v12, v54, v162
    v_dot2_f32_bf16 v170, v27, v41, v170
    v_dot2_f32_bf16 v171, v27, v55, v171
    v_dot2_f32_bf16 v162, v13, v55, v162
    v_dot2_f32_bf16 v170, v28, v42, v170
    v_dot2_f32_bf16 v171, v28, v56, v171
    v_dot2_f32_bf16 v162, v14, v56, v162
    v_dot2_f32_bf16 v170, v29, v43, v170
    v_dot2_f32_bf16 v171, v29, v57, v171
    v_dot2_f32_bf16 v162, v15, v57, v162
    v_dot2_f32_bf16 v170, v30, v44, v170
    v_dot2_f32_bf16 v171, v30, v58, v171
    v_dot2_f32_bf16 v162, v16, v58, v162
    v_dot2_f32_bf16 v170, v31, v45, v170
    v_dot2_f32_bf16 v171, v31, v59, v171
    v_dot2_f32_bf16 v162, v17, v59, v162
    v_dot2_f32_bf16 v170, v32, v46, v170
    v_dot2_f32_bf16 v171, v32, v60, v171
    v_dot2_f32_bf16 v162, v18, v60, v162
    v_dot2_f32_bf16 v170, v33, v47, v170
    v_dot2_f32_bf16 v171, v33, v61, v171
    v_dot2_f32_bf16 v162, v19, v61, v162
    v_dot2_f32_bf16 v170, v34, v48, v170
    v_dot2_f32_bf16 v171, v34, v62, v171
    v_dot2_f32_bf16 v162, v20, v62, v162
    v_dot2_f32_bf16 v170, v35, v49, v170
    v_dot2_f32_bf16 v171, v35, v63, v171
    v_dot2_f32_bf16 v162, v21, v63, v162
    v_dot2_f32_bf16 v172, v22, v64, 0
    v_dot2_f32_bf16 v163, v8, v64, 0
    v_dot2_f32_bf16 v173, v22, v78, 0
    v_dot2_f32_bf16 v164, v8, v78, 0
    v_dot2_f32_bf16 v172, v23, v65, v172
    v_dot2_f32_bf16 v163, v9, v65, v163
    v_dot2_f32_bf16 v173, v23, v79, v173
    v_dot2_f32_bf16 v164, v9, v79, v164
    v_dot2_f32_bf16 v172, v24, v66, v172
    v_dot2_f32_bf16 v163, v10, v66, v163
    v_dot2_f32_bf16 v173, v24, v80, v173
    v_dot2_f32_bf16 v164, v10, v80, v164
    v_dot2_f32_bf16 v172, v25, v67, v172
    v_dot2_f32_bf16 v163, v11, v67, v163
    v_dot2_f32_bf16 v173, v25, v81, v173
    v_dot2_f32_bf16 v164, v11, v81, v164
    v_dot2_f32_bf16 v172, v26, v68, v172
    v_dot2_f32_bf16 v163, v12, v68, v163
    v_dot2_f32_bf16 v173, v26, v82, v173
    v_dot2_f32_bf16 v164, v12, v82, v164
    v_dot2_f32_bf16 v172, v27, v69, v172
    v_dot2_f32_bf16 v163, v13, v69, v163
    v_dot2_f32_bf16 v173, v27, v83, v173
    v_dot2_f32_bf16 v164, v13, v83, v164
    v_dot2_f32_bf16 v172, v28, v70, v172
    v_dot2_f32_bf16 v163, v14, v70, v163
    v_dot2_f32_bf16 v173, v28, v84, v173
    v_dot2_f32_bf16 v164, v14, v84, v164
    v_dot2_f32_bf16 v172, v29, v71, v172
    v_dot2_f32_bf16 v163, v15, v71, v163
    v_dot2_f32_bf16 v173, v29, v85, v173
    v_dot2_f32_bf16 v164, v15, v85, v164
    v_dot2_f32_bf16 v172, v30, v72, v172
    v_dot2_f32_bf16 v163, v16, v72, v163
    v_dot2_f32_bf16 v173, v30, v86, v173
    v_dot2_f32_bf16 v164, v16, v86, v164
    v_dot2_f32_bf16 v172, v31, v73, v172
    v_dot2_f32_bf16 v163, v17, v73, v163
    v_dot2_f32_bf16 v173, v31, v87, v173
    v_dot2_f32_bf16 v164, v17, v87, v164
    v_dot2_f32_bf16 v172, v32, v74, v172
    v_dot2_f32_bf16 v163, v18, v74, v163
    v_dot2_f32_bf16 v173, v32, v88, v173
    v_dot2_f32_bf16 v164, v18, v88, v164
    v_dot2_f32_bf16 v172, v33, v75, v172
    v_dot2_f32_bf16 v163, v19, v75, v163
    v_dot2_f32_bf16 v173, v33, v89, v173
    v_dot2_f32_bf16 v164, v19, v89, v164
    v_dot2_f32_bf16 v172, v34, v76, v172
    v_dot2_f32_bf16 v163, v20, v76, v163
    v_dot2_f32_bf16 v173, v34, v90, v173
    v_dot2_f32_bf16 v164, v20, v90, v164
    v_dot2_f32_bf16 v172, v35, v77, v172
    v_dot2_f32_bf16 v163, v21, v77, v163
    v_dot2_f32_bf16 v173, v35, v91, v173
    v_dot2_f32_bf16 v164, v21, v91, v164
    s_waitcnt vmcnt(0)
    s_barrier
    ds_read_b64 v[36:37], v242 offset:31616
    ds_read_b64 v[38:39], v242 offset:31624
    ds_read_b64 v[40:41], v242 offset:31632
    ds_read_b64 v[42:43], v242 offset:31640
    ds_read_b64 v[44:45], v242 offset:31648
    ds_read_b64 v[46:47], v242 offset:31656
    ds_read_b64 v[48:49], v242 offset:31664
    ds_read_b64 v[50:51], v242 offset:27776
    ds_read_b64 v[52:53], v242 offset:27784
    ds_read_b64 v[54:55], v242 offset:27792
    ds_read_b64 v[56:57], v242 offset:27800
    ds_read_b64 v[58:59], v242 offset:27808
    ds_read_b64 v[60:61], v242 offset:27816
    ds_read_b64 v[62:63], v242 offset:27824
    ds_read_b64 v[64:65], v242 offset:23936
    ds_read_b64 v[66:67], v242 offset:23944
    ds_read_b64 v[68:69], v242 offset:23952
    ds_read_b64 v[70:71], v242 offset:23960
    ds_read_b64 v[72:73], v242 offset:23968
    ds_read_b64 v[74:75], v242 offset:23976
    ds_read_b64 v[76:77], v242 offset:23984
    ds_read_b64 v[78:79], v242 offset:20096
    ds_read_b64 v[80:81], v242 offset:20104
    ds_read_b64 v[82:83], v242 offset:20112
    ds_read_b64 v[84:85], v242 offset:20120
    ds_read_b64 v[86:87], v242 offset:20128
    ds_read_b64 v[88:89], v242 offset:20136
    ds_read_b64 v[90:91], v242 offset:20144
    v_dot2_f32_bf16 v174, v22, v92, 0
    v_dot2_f32_bf16 v165, v8, v92, 0
    v_dot2_f32_bf16 v175, v22, v106, 0
    v_dot2_f32_bf16 v166, v8, v106, 0
    v_dot2_f32_bf16 v174, v23, v93, v174
    v_dot2_f32_bf16 v165, v9, v93, v165
    v_dot2_f32_bf16 v175, v23, v107, v175
    v_dot2_f32_bf16 v166, v9, v107, v166
    v_dot2_f32_bf16 v174, v24, v94, v174
    v_dot2_f32_bf16 v165, v10, v94, v165
    v_dot2_f32_bf16 v175, v24, v108, v175
    v_dot2_f32_bf16 v166, v10, v108, v166
    v_dot2_f32_bf16 v174, v25, v95, v174
    v_dot2_f32_bf16 v165, v11, v95, v165
    v_dot2_f32_bf16 v175, v25, v109, v175
    v_dot2_f32_bf16 v166, v11, v109, v166
    v_dot2_f32_bf16 v174, v26, v96, v174
    v_dot2_f32_bf16 v165, v12, v96, v165
    v_dot2_f32_bf16 v175, v26, v110, v175
    v_dot2_f32_bf16 v166, v12, v110, v166
    v_dot2_f32_bf16 v174, v27, v97, v174
    v_dot2_f32_bf16 v165, v13, v97, v165
    v_dot2_f32_bf16 v175, v27, v111, v175
    v_dot2_f32_bf16 v166, v13, v111, v166
    v_dot2_f32_bf16 v174, v28, v98, v174
    v_dot2_f32_bf16 v165, v14, v98, v165
    v_dot2_f32_bf16 v175, v28, v112, v175
    v_dot2_f32_bf16 v166, v14, v112, v166
    v_dot2_f32_bf16 v174, v29, v99, v174
    v_dot2_f32_bf16 v165, v15, v99, v165
    v_dot2_f32_bf16 v175, v29, v113, v175
    v_dot2_f32_bf16 v166, v15, v113, v166
    v_dot2_f32_bf16 v174, v30, v100, v174
    v_dot2_f32_bf16 v165, v16, v100, v165
    v_dot2_f32_bf16 v175, v30, v114, v175
    v_dot2_f32_bf16 v166, v16, v114, v166
    v_dot2_f32_bf16 v174, v31, v101, v174
    v_dot2_f32_bf16 v165, v17, v101, v165
    v_dot2_f32_bf16 v175, v31, v115, v175
    v_dot2_f32_bf16 v166, v17, v115, v166
    v_dot2_f32_bf16 v174, v32, v102, v174
    v_dot2_f32_bf16 v165, v18, v102, v165
    v_dot2_f32_bf16 v175, v32, v116, v175
    v_dot2_f32_bf16 v166, v18, v116, v166
    v_dot2_f32_bf16 v174, v33, v103, v174
    v_dot2_f32_bf16 v165, v19, v103, v165
    v_dot2_f32_bf16 v175, v33, v117, v175
    v_dot2_f32_bf16 v166, v19, v117, v166
    v_dot2_f32_bf16 v174, v34, v104, v174
    v_dot2_f32_bf16 v165, v20, v104, v165
    v_dot2_f32_bf16 v175, v34, v118, v175
    v_dot2_f32_bf16 v166, v20, v118, v166
    v_dot2_f32_bf16 v174, v35, v105, v174
    v_dot2_f32_bf16 v165, v21, v105, v165
    v_dot2_f32_bf16 v175, v35, v119, v175
    v_dot2_f32_bf16 v166, v21, v119, v166
    ds_read_b64 v[92:93], v242 offset:16256
    ds_read_b64 v[94:95], v242 offset:16264
    ds_read_b64 v[96:97], v242 offset:16272
    ds_read_b64 v[98:99], v242 offset:16280
    ds_read_b64 v[100:101], v242 offset:16288
    ds_read_b64 v[102:103], v242 offset:16296
    ds_read_b64 v[104:105], v242 offset:16304
    ds_read_b64 v[106:107], v242 offset:12416
    ds_read_b64 v[108:109], v242 offset:12424
    ds_read_b64 v[110:111], v242 offset:12432
    ds_read_b64 v[112:113], v242 offset:12440
    ds_read_b64 v[114:115], v242 offset:12448
    ds_read_b64 v[116:117], v242 offset:12456
    ds_read_b64 v[118:119], v242 offset:12464
    s_waitcnt lgkmcnt(15)
    v_dot2_f32_bf16 v176, v22, v120, 0
    v_dot2_f32_bf16 v167, v8, v120, 0
    v_dot2_f32_bf16 v177, v22, v134, 0
    v_dot2_f32_bf16 v168, v8, v134, 0
    v_dot2_f32_bf16 v176, v23, v121, v176
    v_dot2_f32_bf16 v167, v9, v121, v167
    v_dot2_f32_bf16 v177, v23, v135, v177
    v_dot2_f32_bf16 v168, v9, v135, v168
    v_dot2_f32_bf16 v176, v24, v122, v176
    v_dot2_f32_bf16 v167, v10, v122, v167
    v_dot2_f32_bf16 v177, v24, v136, v177
    v_dot2_f32_bf16 v168, v10, v136, v168
    v_dot2_f32_bf16 v176, v25, v123, v176
    v_dot2_f32_bf16 v167, v11, v123, v167
    v_dot2_f32_bf16 v177, v25, v137, v177
    v_dot2_f32_bf16 v168, v11, v137, v168
    v_dot2_f32_bf16 v176, v26, v124, v176
    v_dot2_f32_bf16 v167, v12, v124, v167
    v_dot2_f32_bf16 v177, v26, v138, v177
    v_dot2_f32_bf16 v168, v12, v138, v168
    v_dot2_f32_bf16 v176, v27, v125, v176
    v_dot2_f32_bf16 v167, v13, v125, v167
    v_dot2_f32_bf16 v177, v27, v139, v177
    v_dot2_f32_bf16 v168, v13, v139, v168
    v_dot2_f32_bf16 v176, v28, v126, v176
    v_dot2_f32_bf16 v167, v14, v126, v167
    v_dot2_f32_bf16 v177, v28, v140, v177
    v_dot2_f32_bf16 v168, v14, v140, v168
    v_dot2_f32_bf16 v176, v29, v127, v176
    v_dot2_f32_bf16 v167, v15, v127, v167
    v_dot2_f32_bf16 v177, v29, v141, v177
    v_dot2_f32_bf16 v168, v15, v141, v168
    v_dot2_f32_bf16 v176, v30, v128, v176
    v_dot2_f32_bf16 v167, v16, v128, v167
    v_dot2_f32_bf16 v177, v30, v142, v177
    v_dot2_f32_bf16 v168, v16, v142, v168
    v_dot2_f32_bf16 v176, v31, v129, v176
    v_dot2_f32_bf16 v167, v17, v129, v167
    v_dot2_f32_bf16 v177, v31, v143, v177
    v_dot2_f32_bf16 v168, v17, v143, v168
    v_dot2_f32_bf16 v176, v32, v130, v176
    v_dot2_f32_bf16 v167, v18, v130, v167
    v_dot2_f32_bf16 v177, v32, v144, v177
    v_dot2_f32_bf16 v168, v18, v144, v168
    v_dot2_f32_bf16 v176, v33, v131, v176
    v_dot2_f32_bf16 v167, v19, v131, v167
    v_dot2_f32_bf16 v177, v33, v145, v177
    v_dot2_f32_bf16 v168, v19, v145, v168
    v_dot2_f32_bf16 v176, v34, v132, v176
    v_dot2_f32_bf16 v167, v20, v132, v167
    v_dot2_f32_bf16 v177, v34, v146, v177
    v_dot2_f32_bf16 v168, v20, v146, v168
    v_dot2_f32_bf16 v176, v35, v133, v176
    v_dot2_f32_bf16 v167, v21, v133, v167
    v_dot2_f32_bf16 v177, v35, v147, v177
    v_dot2_f32_bf16 v168, v21, v147, v168
    ds_read_b64 v[120:121], v242 offset:8576
    ds_read_b64 v[122:123], v242 offset:8584
    ds_read_b64 v[124:125], v242 offset:8592
    ds_read_b64 v[126:127], v242 offset:8600
    ds_read_b64 v[128:129], v242 offset:8608
    ds_read_b64 v[130:131], v242 offset:8616
    ds_read_b64 v[132:133], v242 offset:8624
    ds_read_b64 v[134:135], v242 offset:4736
    ds_read_b64 v[136:137], v242 offset:4744
    ds_read_b64 v[138:139], v242 offset:4752
    ds_read_b64 v[140:141], v242 offset:4760
    ds_read_b64 v[142:143], v242 offset:4768
    ds_read_b64 v[144:145], v242 offset:4776
    ds_read_b64 v[146:147], v242 offset:4784
    v_dot2_f32_bf16 v169, v8, v148, 0
    v_dot2_f32_bf16 v169, v9, v149, v169
    v_dot2_f32_bf16 v169, v10, v150, v169
    v_dot2_f32_bf16 v169, v11, v151, v169
    v_dot2_f32_bf16 v169, v12, v152, v169
    v_dot2_f32_bf16 v169, v13, v153, v169
    v_dot2_f32_bf16 v169, v14, v154, v169
    v_dot2_f32_bf16 v169, v15, v155, v169
    v_dot2_f32_bf16 v169, v16, v156, v169
    v_dot2_f32_bf16 v169, v17, v157, v169
    v_dot2_f32_bf16 v169, v18, v158, v169
    v_dot2_f32_bf16 v169, v19, v159, v169
    v_dot2_f32_bf16 v169, v20, v160, v169
    v_dot2_f32_bf16 v169, v21, v161, v169
    ds_read_b64 v[148:149], v242 offset:896
    ds_read_b64 v[150:151], v242 offset:904
    ds_read_b64 v[152:153], v242 offset:912
    ds_read_b64 v[154:155], v242 offset:920
    ds_read_b64 v[156:157], v242 offset:928
    ds_read_b64 v[158:159], v242 offset:936
    ds_read_b64 v[160:161], v242 offset:944
    s_cmp_lg_u32 s48, 0
    s_cbranch_scc1 am_f_24
    v_mov_b32 v246, 0xce6e6b28
    v_add_u32 v247, 2, v245
    v_cmp_le_u32 vcc, 2, v245
    s_nop 1
    v_cndmask_b32 v163, v246, v163, vcc
    v_cmp_le_u32 vcc, 2, v247
    s_nop 1
    v_cndmask_b32 v171, v246, v171, vcc
    v_cmp_le_u32 vcc, 4, v245
    s_nop 1
    v_cndmask_b32 v164, v246, v164, vcc
    v_cmp_le_u32 vcc, 4, v247
    s_nop 1
    v_cndmask_b32 v172, v246, v172, vcc
    v_cmp_le_u32 vcc, 6, v245
    s_nop 1
    v_cndmask_b32 v165, v246, v165, vcc
    v_cmp_le_u32 vcc, 6, v247
    s_nop 1
    v_cndmask_b32 v173, v246, v173, vcc
    v_cmp_le_u32 vcc, 8, v245
    s_nop 1
    v_cndmask_b32 v166, v246, v166, vcc
    v_cmp_le_u32 vcc, 8, v247
    s_nop 1
    v_cndmask_b32 v174, v246, v174, vcc
    v_cmp_le_u32 vcc, 10, v245
    s_nop 1
    v_cndmask_b32 v167, v246, v167, vcc
    v_cmp_le_u32 vcc, 10, v247
    s_nop 1
    v_cndmask_b32 v175, v246, v175, vcc
    v_cmp_le_u32 vcc, 12, v245
    s_nop 1
    v_cndmask_b32 v168, v246, v168, vcc
    v_cmp_le_u32 vcc, 12, v247
    s_nop 1
    v_cndmask_b32 v176, v246, v176, vcc
    v_cmp_le_u32 vcc, 14, v245
    s_nop 1
    v_cndmask_b32 v169, v246, v169, vcc
    v_cmp_le_u32 vcc, 14, v247
    s_nop 1
    v_cndmask_b32 v177, v246, v177, vcc
am_f_24:
    s_mov_b32 s50, 0x3e8b97f6
    v_max3_f32 v246, v162, v163, v164
    v_max3_f32 v247, v170, v171, v172
    v_max3_f32 v246, v246, v165, v166
    v_max3_f32 v247, v247, v173, v174
    v_max3_f32 v246, v246, v167, v168
    v_max3_f32 v247, v247, v175, v176
    v_max_f32 v246, v246, v169
    v_max_f32 v247, v247, v177
    v_mul_f32 v246, 0xbe8b97f6, v246
    v_mul_f32 v247, 0xbe8b97f6, v247
    v_fma_f32 v162, v162, s50, v246
    v_fma_f32 v170, v170, s50, v247
    v_fma_f32 v163, v163, s50, v246
    v_fma_f32 v171, v171, s50, v247
    v_fma_f32 v164, v164, s50, v246
    v_fma_f32 v172, v172, s50, v247
    v_fma_f32 v165, v165, s50, v246
    v_fma_f32 v173, v173, s50, v247
    v_fma_f32 v166, v166, s50, v246
    v_fma_f32 v174, v174, s50, v247
    v_fma_f32 v167, v167, s50, v246
    v_fma_f32 v175, v175, s50, v247
    v_fma_f32 v168, v168, s50, v246
    v_fma_f32 v176, v176, s50, v247
    v_fma_f32 v169, v169, s50, v246
    v_fma_f32 v177, v177, s50, v247
    v_exp_f32 v162, v162
    v_exp_f32 v170, v170
    v_exp_f32 v163, v163
    v_exp_f32 v171, v171
    v_exp_f32 v164, v164
    v_exp_f32 v172, v172
    v_exp_f32 v165, v165
    v_exp_f32 v173, v173
    v_exp_f32 v166, v166
    v_exp_f32 v174, v174
    v_exp_f32 v167, v167
    v_exp_f32 v175, v175
    v_exp_f32 v168, v168
    v_exp_f32 v176, v176
    v_exp_f32 v169, v169
    v_exp_f32 v177, v177
    v_add_f32 v234, v162, v163
    v_add_f32 v235, v164, v165
    v_add_f32 v236, v166, v167
    v_add_f32 v237, v168, v169
    v_add_f32 v238, v170, v171
    v_add_f32 v239, v172, v173
    v_add_f32 v240, v174, v175
    v_add_f32 v241, v176, v177
    v_add_f32 v234, v234, v235
    v_add_f32 v236, v236, v237
    v_add_f32 v238, v238, v239
    v_add_f32 v240, v240, v241
    v_add_f32 v234, v234, v236
    v_add_f32 v238, v238, v240
    v_rcp_f32 v246, v234
    v_rcp_f32 v247, v238
    v_mul_f32 v162, v162, v246
    v_mul_f32 v170, v170, v247
    v_mul_f32 v163, v163, v246
    v_mul_f32 v171, v171, v247
    v_mul_f32 v164, v164, v246
    v_mul_f32 v172, v172, v247
    v_mul_f32 v165, v165, v246
    v_mul_f32 v173, v173, v247
    v_mul_f32 v166, v166, v246
    v_mul_f32 v174, v174, v247
    v_mul_f32 v167, v167, v246
    v_mul_f32 v175, v175, v247
    v_mul_f32 v168, v168, v246
    v_mul_f32 v176, v176, v247
    v_mul_f32 v169, v169, v246
    v_mul_f32 v177, v177, v247
    v_cvt_pk_bf16_f32 v234, v162, v163
    v_cvt_pk_bf16_f32 v235, v164, v165
    v_cvt_pk_bf16_f32 v236, v166, v167
    v_cvt_pk_bf16_f32 v237, v168, v169
    v_cvt_pk_bf16_f32 v238, v171, v172
    v_cvt_pk_bf16_f32 v239, v173, v174
    v_cvt_pk_bf16_f32 v240, v175, v176
    v_cvt_pk_bf16_f32 v241, v170, v177
    s_mov_b32 s54, 0x05040100
    s_mov_b32 s55, 0x07060302
    v_perm_b32 v8, v64, v50, s54
    v_perm_b32 v9, v64, v50, s55
    v_perm_b32 v10, v65, v51, s54
    v_perm_b32 v11, v65, v51, s55
    v_perm_b32 v12, v66, v52, s54
    v_perm_b32 v13, v66, v52, s55
    v_perm_b32 v14, v67, v53, s54
    v_perm_b32 v15, v67, v53, s55
    v_perm_b32 v16, v68, v54, s54
    v_perm_b32 v17, v68, v54, s55
    v_perm_b32 v18, v69, v55, s54
    v_perm_b32 v19, v69, v55, s55
    v_perm_b32 v20, v70, v56, s54
    v_perm_b32 v21, v70, v56, s55
    v_perm_b32 v22, v71, v57, s54
    v_perm_b32 v23, v71, v57, s55
    v_perm_b32 v24, v72, v58, s54
    v_perm_b32 v25, v72, v58, s55
    v_perm_b32 v26, v73, v59, s54
    v_perm_b32 v27, v73, v59, s55
    v_perm_b32 v28, v74, v60, s54
    v_perm_b32 v29, v74, v60, s55
    v_perm_b32 v30, v75, v61, s54
    v_perm_b32 v31, v75, v61, s55
    v_perm_b32 v32, v76, v62, s54
    v_perm_b32 v33, v76, v62, s55
    v_perm_b32 v34, v77, v63, s54
    v_perm_b32 v35, v77, v63, s55
    v_dot2_f32_bf16 v178, v8, v234, 0
    v_dot2_f32_bf16 v206, v8, v238, 0
    v_dot2_f32_bf16 v179, v9, v234, 0
    v_dot2_f32_bf16 v207, v9, v238, 0
    v_dot2_f32_bf16 v180, v10, v234, 0
    v_dot2_f32_bf16 v208, v10, v238, 0
    v_dot2_f32_bf16 v181, v11, v234, 0
    v_dot2_f32_bf16 v209, v11, v238, 0
    v_dot2_f32_bf16 v182, v12, v234, 0
    v_dot2_f32_bf16 v210, v12, v238, 0
    v_dot2_f32_bf16 v183, v13, v234, 0
    v_dot2_f32_bf16 v211, v13, v238, 0
    v_dot2_f32_bf16 v184, v14, v234, 0
    v_dot2_f32_bf16 v212, v14, v238, 0
    v_dot2_f32_bf16 v185, v15, v234, 0
    v_dot2_f32_bf16 v213, v15, v238, 0
    v_dot2_f32_bf16 v186, v16, v234, 0
    v_dot2_f32_bf16 v214, v16, v238, 0
    v_dot2_f32_bf16 v187, v17, v234, 0
    v_dot2_f32_bf16 v215, v17, v238, 0
    v_dot2_f32_bf16 v188, v18, v234, 0
    v_dot2_f32_bf16 v216, v18, v238, 0
    v_dot2_f32_bf16 v189, v19, v234, 0
    v_dot2_f32_bf16 v217, v19, v238, 0
    v_dot2_f32_bf16 v190, v20, v234, 0
    v_dot2_f32_bf16 v218, v20, v238, 0
    v_dot2_f32_bf16 v191, v21, v234, 0
    v_dot2_f32_bf16 v219, v21, v238, 0
    v_dot2_f32_bf16 v192, v22, v234, 0
    v_dot2_f32_bf16 v220, v22, v238, 0
    v_dot2_f32_bf16 v193, v23, v234, 0
    v_dot2_f32_bf16 v221, v23, v238, 0
    v_dot2_f32_bf16 v194, v24, v234, 0
    v_dot2_f32_bf16 v222, v24, v238, 0
    v_dot2_f32_bf16 v195, v25, v234, 0
    v_dot2_f32_bf16 v223, v25, v238, 0
    v_dot2_f32_bf16 v196, v26, v234, 0
    v_dot2_f32_bf16 v224, v26, v238, 0
    v_dot2_f32_bf16 v197, v27, v234, 0
    v_dot2_f32_bf16 v225, v27, v238, 0
    v_dot2_f32_bf16 v198, v28, v234, 0
    v_dot2_f32_bf16 v226, v28, v238, 0
    v_dot2_f32_bf16 v199, v29, v234, 0
    v_dot2_f32_bf16 v227, v29, v238, 0
    v_dot2_f32_bf16 v200, v30, v234, 0
    v_dot2_f32_bf16 v228, v30, v238, 0
    v_dot2_f32_bf16 v201, v31, v234, 0
    v_dot2_f32_bf16 v229, v31, v238, 0
    v_dot2_f32_bf16 v202, v32, v234, 0
    v_dot2_f32_bf16 v230, v32, v238, 0
    v_dot2_f32_bf16 v203, v33, v234, 0
    v_dot2_f32_bf16 v231, v33, v238, 0
    v_dot2_f32_bf16 v204, v34, v234, 0
    v_dot2_f32_bf16 v232, v34, v238, 0
    v_dot2_f32_bf16 v205, v35, v234, 0
    v_dot2_f32_bf16 v233, v35, v238, 0
    s_waitcnt lgkmcnt(15)
    v_perm_b32 v8, v92, v78, s54
    v_perm_b32 v9, v92, v78, s55
    v_perm_b32 v10, v93, v79, s54
    v_perm_b32 v11, v93, v79, s55
    v_perm_b32 v12, v94, v80, s54
    v_perm_b32 v13, v94, v80, s55
    v_perm_b32 v14, v95, v81, s54
    v_perm_b32 v15, v95, v81, s55
    v_perm_b32 v16, v96, v82, s54
    v_perm_b32 v17, v96, v82, s55
    v_perm_b32 v18, v97, v83, s54
    v_perm_b32 v19, v97, v83, s55
    v_perm_b32 v20, v98, v84, s54
    v_perm_b32 v21, v98, v84, s55
    v_perm_b32 v22, v99, v85, s54
    v_perm_b32 v23, v99, v85, s55
    v_perm_b32 v24, v100, v86, s54
    v_perm_b32 v25, v100, v86, s55
    v_perm_b32 v26, v101, v87, s54
    v_perm_b32 v27, v101, v87, s55
    v_perm_b32 v28, v102, v88, s54
    v_perm_b32 v29, v102, v88, s55
    v_perm_b32 v30, v103, v89, s54
    v_perm_b32 v31, v103, v89, s55
    v_perm_b32 v32, v104, v90, s54
    v_perm_b32 v33, v104, v90, s55
    v_perm_b32 v34, v105, v91, s54
    v_perm_b32 v35, v105, v91, s55
    v_dot2_f32_bf16 v178, v8, v235, v178
    v_dot2_f32_bf16 v206, v8, v239, v206
    v_dot2_f32_bf16 v179, v9, v235, v179
    v_dot2_f32_bf16 v207, v9, v239, v207
    v_dot2_f32_bf16 v180, v10, v235, v180
    v_dot2_f32_bf16 v208, v10, v239, v208
    v_dot2_f32_bf16 v181, v11, v235, v181
    v_dot2_f32_bf16 v209, v11, v239, v209
    v_dot2_f32_bf16 v182, v12, v235, v182
    v_dot2_f32_bf16 v210, v12, v239, v210
    v_dot2_f32_bf16 v183, v13, v235, v183
    v_dot2_f32_bf16 v211, v13, v239, v211
    v_dot2_f32_bf16 v184, v14, v235, v184
    v_dot2_f32_bf16 v212, v14, v239, v212
    v_dot2_f32_bf16 v185, v15, v235, v185
    v_dot2_f32_bf16 v213, v15, v239, v213
    v_dot2_f32_bf16 v186, v16, v235, v186
    v_dot2_f32_bf16 v214, v16, v239, v214
    v_dot2_f32_bf16 v187, v17, v235, v187
    v_dot2_f32_bf16 v215, v17, v239, v215
    v_dot2_f32_bf16 v188, v18, v235, v188
    v_dot2_f32_bf16 v216, v18, v239, v216
    v_dot2_f32_bf16 v189, v19, v235, v189
    v_dot2_f32_bf16 v217, v19, v239, v217
    v_dot2_f32_bf16 v190, v20, v235, v190
    v_dot2_f32_bf16 v218, v20, v239, v218
    v_dot2_f32_bf16 v191, v21, v235, v191
    v_dot2_f32_bf16 v219, v21, v239, v219
    v_dot2_f32_bf16 v192, v22, v235, v192
    v_dot2_f32_bf16 v220, v22, v239, v220
    v_dot2_f32_bf16 v193, v23, v235, v193
    v_dot2_f32_bf16 v221, v23, v239, v221
    v_dot2_f32_bf16 v194, v24, v235, v194
    v_dot2_f32_bf16 v222, v24, v239, v222
    v_dot2_f32_bf16 v195, v25, v235, v195
    v_dot2_f32_bf16 v223, v25, v239, v223
    v_dot2_f32_bf16 v196, v26, v235, v196
    v_dot2_f32_bf16 v224, v26, v239, v224
    v_dot2_f32_bf16 v197, v27, v235, v197
    v_dot2_f32_bf16 v225, v27, v239, v225
    v_dot2_f32_bf16 v198, v28, v235, v198
    v_dot2_f32_bf16 v226, v28, v239, v226
    v_dot2_f32_bf16 v199, v29, v235, v199
    v_dot2_f32_bf16 v227, v29, v239, v227
    v_dot2_f32_bf16 v200, v30, v235, v200
    v_dot2_f32_bf16 v228, v30, v239, v228
    v_dot2_f32_bf16 v201, v31, v235, v201
    v_dot2_f32_bf16 v229, v31, v239, v229
    v_dot2_f32_bf16 v202, v32, v235, v202
    v_dot2_f32_bf16 v230, v32, v239, v230
    v_dot2_f32_bf16 v203, v33, v235, v203
    v_dot2_f32_bf16 v231, v33, v239, v231
    v_dot2_f32_bf16 v204, v34, v235, v204
    v_dot2_f32_bf16 v232, v34, v239, v232
    v_dot2_f32_bf16 v205, v35, v235, v205
    v_dot2_f32_bf16 v233, v35, v239, v233
    s_waitcnt lgkmcnt(14)
    v_perm_b32 v8, v120, v106, s54
    v_perm_b32 v9, v120, v106, s55
    v_perm_b32 v10, v121, v107, s54
    v_perm_b32 v11, v121, v107, s55
    v_perm_b32 v12, v122, v108, s54
    v_perm_b32 v13, v122, v108, s55
    v_perm_b32 v14, v123, v109, s54
    v_perm_b32 v15, v123, v109, s55
    v_perm_b32 v16, v124, v110, s54
    v_perm_b32 v17, v124, v110, s55
    v_perm_b32 v18, v125, v111, s54
    v_perm_b32 v19, v125, v111, s55
    v_perm_b32 v20, v126, v112, s54
    v_perm_b32 v21, v126, v112, s55
    v_perm_b32 v22, v127, v113, s54
    v_perm_b32 v23, v127, v113, s55
    v_perm_b32 v24, v128, v114, s54
    v_perm_b32 v25, v128, v114, s55
    v_perm_b32 v26, v129, v115, s54
    v_perm_b32 v27, v129, v115, s55
    v_perm_b32 v28, v130, v116, s54
    v_perm_b32 v29, v130, v116, s55
    v_perm_b32 v30, v131, v117, s54
    v_perm_b32 v31, v131, v117, s55
    v_perm_b32 v32, v132, v118, s54
    v_perm_b32 v33, v132, v118, s55
    v_perm_b32 v34, v133, v119, s54
    v_perm_b32 v35, v133, v119, s55
    v_dot2_f32_bf16 v178, v8, v236, v178
    v_dot2_f32_bf16 v206, v8, v240, v206
    v_dot2_f32_bf16 v179, v9, v236, v179
    v_dot2_f32_bf16 v207, v9, v240, v207
    v_dot2_f32_bf16 v180, v10, v236, v180
    v_dot2_f32_bf16 v208, v10, v240, v208
    v_dot2_f32_bf16 v181, v11, v236, v181
    v_dot2_f32_bf16 v209, v11, v240, v209
    v_dot2_f32_bf16 v182, v12, v236, v182
    v_dot2_f32_bf16 v210, v12, v240, v210
    v_dot2_f32_bf16 v183, v13, v236, v183
    v_dot2_f32_bf16 v211, v13, v240, v211
    v_dot2_f32_bf16 v184, v14, v236, v184
    v_dot2_f32_bf16 v212, v14, v240, v212
    v_dot2_f32_bf16 v185, v15, v236, v185
    v_dot2_f32_bf16 v213, v15, v240, v213
    v_dot2_f32_bf16 v186, v16, v236, v186
    v_dot2_f32_bf16 v214, v16, v240, v214
    v_dot2_f32_bf16 v187, v17, v236, v187
    v_dot2_f32_bf16 v215, v17, v240, v215
    v_dot2_f32_bf16 v188, v18, v236, v188
    v_dot2_f32_bf16 v216, v18, v240, v216
    v_dot2_f32_bf16 v189, v19, v236, v189
    v_dot2_f32_bf16 v217, v19, v240, v217
    v_dot2_f32_bf16 v190, v20, v236, v190
    v_dot2_f32_bf16 v218, v20, v240, v218
    v_dot2_f32_bf16 v191, v21, v236, v191
    v_dot2_f32_bf16 v219, v21, v240, v219
    v_dot2_f32_bf16 v192, v22, v236, v192
    v_dot2_f32_bf16 v220, v22, v240, v220
    v_dot2_f32_bf16 v193, v23, v236, v193
    v_dot2_f32_bf16 v221, v23, v240, v221
    v_dot2_f32_bf16 v194, v24, v236, v194
    v_dot2_f32_bf16 v222, v24, v240, v222
    v_dot2_f32_bf16 v195, v25, v236, v195
    v_dot2_f32_bf16 v223, v25, v240, v223
    v_dot2_f32_bf16 v196, v26, v236, v196
    v_dot2_f32_bf16 v224, v26, v240, v224
    v_dot2_f32_bf16 v197, v27, v236, v197
    v_dot2_f32_bf16 v225, v27, v240, v225
    v_dot2_f32_bf16 v198, v28, v236, v198
    v_dot2_f32_bf16 v226, v28, v240, v226
    v_dot2_f32_bf16 v199, v29, v236, v199
    v_dot2_f32_bf16 v227, v29, v240, v227
    v_dot2_f32_bf16 v200, v30, v236, v200
    v_dot2_f32_bf16 v228, v30, v240, v228
    v_dot2_f32_bf16 v201, v31, v236, v201
    v_dot2_f32_bf16 v229, v31, v240, v229
    v_dot2_f32_bf16 v202, v32, v236, v202
    v_dot2_f32_bf16 v230, v32, v240, v230
    v_dot2_f32_bf16 v203, v33, v236, v203
    v_dot2_f32_bf16 v231, v33, v240, v231
    v_dot2_f32_bf16 v204, v34, v236, v204
    v_dot2_f32_bf16 v232, v34, v240, v232
    v_dot2_f32_bf16 v205, v35, v236, v205
    v_dot2_f32_bf16 v233, v35, v240, v233
    s_waitcnt lgkmcnt(0)
    v_perm_b32 v8, v148, v134, s54
    v_perm_b32 v9, v148, v134, s55
    v_perm_b32 v10, v149, v135, s54
    v_perm_b32 v11, v149, v135, s55
    v_perm_b32 v12, v150, v136, s54
    v_perm_b32 v13, v150, v136, s55
    v_perm_b32 v14, v151, v137, s54
    v_perm_b32 v15, v151, v137, s55
    v_perm_b32 v16, v152, v138, s54
    v_perm_b32 v17, v152, v138, s55
    v_perm_b32 v18, v153, v139, s54
    v_perm_b32 v19, v153, v139, s55
    v_perm_b32 v20, v154, v140, s54
    v_perm_b32 v21, v154, v140, s55
    v_perm_b32 v22, v155, v141, s54
    v_perm_b32 v23, v155, v141, s55
    v_perm_b32 v24, v156, v142, s54
    v_perm_b32 v25, v156, v142, s55
    v_perm_b32 v26, v157, v143, s54
    v_perm_b32 v27, v157, v143, s55
    v_perm_b32 v28, v158, v144, s54
    v_perm_b32 v29, v158, v144, s55
    v_perm_b32 v30, v159, v145, s54
    v_perm_b32 v31, v159, v145, s55
    v_perm_b32 v32, v160, v146, s54
    v_perm_b32 v33, v160, v146, s55
    v_perm_b32 v34, v161, v147, s54
    v_perm_b32 v35, v161, v147, s55
    v_dot2_f32_bf16 v178, v8, v237, v178
    v_dot2_f32_bf16 v179, v9, v237, v179
    v_dot2_f32_bf16 v180, v10, v237, v180
    v_dot2_f32_bf16 v181, v11, v237, v181
    v_dot2_f32_bf16 v182, v12, v237, v182
    v_dot2_f32_bf16 v183, v13, v237, v183
    v_dot2_f32_bf16 v184, v14, v237, v184
    v_dot2_f32_bf16 v185, v15, v237, v185
    v_dot2_f32_bf16 v186, v16, v237, v186
    v_dot2_f32_bf16 v187, v17, v237, v187
    v_dot2_f32_bf16 v188, v18, v237, v188
    v_dot2_f32_bf16 v189, v19, v237, v189
    v_dot2_f32_bf16 v190, v20, v237, v190
    v_dot2_f32_bf16 v191, v21, v237, v191
    v_dot2_f32_bf16 v192, v22, v237, v192
    v_dot2_f32_bf16 v193, v23, v237, v193
    v_dot2_f32_bf16 v194, v24, v237, v194
    v_dot2_f32_bf16 v195, v25, v237, v195
    v_dot2_f32_bf16 v196, v26, v237, v196
    v_dot2_f32_bf16 v197, v27, v237, v197
    v_dot2_f32_bf16 v198, v28, v237, v198
    v_dot2_f32_bf16 v199, v29, v237, v199
    v_dot2_f32_bf16 v200, v30, v237, v200
    v_dot2_f32_bf16 v201, v31, v237, v201
    v_dot2_f32_bf16 v202, v32, v237, v202
    v_dot2_f32_bf16 v203, v33, v237, v203
    v_dot2_f32_bf16 v204, v34, v237, v204
    v_dot2_f32_bf16 v205, v35, v237, v205
    v_perm_b32 v8, v134, v36, s54
    v_perm_b32 v9, v134, v36, s55
    v_perm_b32 v10, v135, v37, s54
    v_perm_b32 v11, v135, v37, s55
    v_perm_b32 v12, v136, v38, s54
    v_perm_b32 v13, v136, v38, s55
    v_perm_b32 v14, v137, v39, s54
    v_perm_b32 v15, v137, v39, s55
    v_perm_b32 v16, v138, v40, s54
    v_perm_b32 v17, v138, v40, s55
    v_perm_b32 v18, v139, v41, s54
    v_perm_b32 v19, v139, v41, s55
    v_perm_b32 v20, v140, v42, s54
    v_perm_b32 v21, v140, v42, s55
    v_perm_b32 v22, v141, v43, s54
    v_perm_b32 v23, v141, v43, s55
    v_perm_b32 v24, v142, v44, s54
    v_perm_b32 v25, v142, v44, s55
    v_perm_b32 v26, v143, v45, s54
    v_perm_b32 v27, v143, v45, s55
    v_perm_b32 v28, v144, v46, s54
    v_perm_b32 v29, v144, v46, s55
    v_perm_b32 v30, v145, v47, s54
    v_perm_b32 v31, v145, v47, s55
    v_perm_b32 v32, v146, v48, s54
    v_perm_b32 v33, v146, v48, s55
    v_perm_b32 v34, v147, v49, s54
    v_perm_b32 v35, v147, v49, s55
    v_dot2_f32_bf16 v206, v8, v241, v206
    v_dot2_f32_bf16 v207, v9, v241, v207
    v_dot2_f32_bf16 v208, v10, v241, v208
    v_dot2_f32_bf16 v209, v11, v241, v209
    v_dot2_f32_bf16 v210, v12, v241, v210
    v_dot2_f32_bf16 v211, v13, v241, v211
    v_dot2_f32_bf16 v212, v14, v241, v212
    v_dot2_f32_bf16 v213, v15, v241, v213
    v_dot2_f32_bf16 v214, v16, v241, v214
    v_dot2_f32_bf16 v215, v17, v241, v215
    v_dot2_f32_bf16 v216, v18, v241, v216
    v_dot2_f32_bf16 v217, v19, v241, v217
    v_dot2_f32_bf16 v218, v20, v241, v218
    v_dot2_f32_bf16 v219, v21, v241, v219
    v_dot2_f32_bf16 v220, v22, v241, v220
    v_dot2_f32_bf16 v221, v23, v241, v221
    v_dot2_f32_bf16 v222, v24, v241, v222
    v_dot2_f32_bf16 v223, v25, v241, v223
    v_dot2_f32_bf16 v224, v26, v241, v224
    v_dot2_f32_bf16 v225, v27, v241, v225
    v_dot2_f32_bf16 v226, v28, v241, v226
    v_dot2_f32_bf16 v227, v29, v241, v227
    v_dot2_f32_bf16 v228, v30, v241, v228
    v_dot2_f32_bf16 v229, v31, v241, v229
    v_dot2_f32_bf16 v230, v32, v241, v230
    v_dot2_f32_bf16 v231, v33, v241, v231
    v_dot2_f32_bf16 v232, v34, v241, v232
    v_dot2_f32_bf16 v233, v35, v241, v233
    v_cvt_pk_bf16_f32 v36, v178, v179
    v_cvt_pk_bf16_f32 v37, v180, v181
    v_cvt_pk_bf16_f32 v38, v182, v183
    v_cvt_pk_bf16_f32 v39, v184, v185
    v_cvt_pk_bf16_f32 v40, v186, v187
    v_cvt_pk_bf16_f32 v41, v188, v189
    v_cvt_pk_bf16_f32 v42, v190, v191
    v_cvt_pk_bf16_f32 v43, v192, v193
    v_cvt_pk_bf16_f32 v44, v194, v195
    v_cvt_pk_bf16_f32 v45, v196, v197
    v_cvt_pk_bf16_f32 v46, v198, v199
    v_cvt_pk_bf16_f32 v47, v200, v201
    v_cvt_pk_bf16_f32 v48, v202, v203
    v_cvt_pk_bf16_f32 v49, v204, v205
    v_cvt_pk_bf16_f32 v50, v206, v207
    v_cvt_pk_bf16_f32 v51, v208, v209
    v_cvt_pk_bf16_f32 v52, v210, v211
    v_cvt_pk_bf16_f32 v53, v212, v213
    v_cvt_pk_bf16_f32 v54, v214, v215
    v_cvt_pk_bf16_f32 v55, v216, v217
    v_cvt_pk_bf16_f32 v56, v218, v219
    v_cvt_pk_bf16_f32 v57, v220, v221
    v_cvt_pk_bf16_f32 v58, v222, v223
    v_cvt_pk_bf16_f32 v59, v224, v225
    v_cvt_pk_bf16_f32 v60, v226, v227
    v_cvt_pk_bf16_f32 v61, v228, v229
    v_cvt_pk_bf16_f32 v62, v230, v231
    v_cvt_pk_bf16_f32 v63, v232, v233
    s_barrier
    v_and_b32 v246, 15, v1
    v_mul_u32_u24 v246, 56, v246
    v_mul_u32_u24 v247, 912, v245
    v_add_u32 v246, v246, v247
    ds_write_b64 v246, v[36:37] offset:0
    ds_write_b64 v246, v[38:39] offset:8
    ds_write_b64 v246, v[40:41] offset:16
    ds_write_b64 v246, v[42:43] offset:24
    ds_write_b64 v246, v[44:45] offset:32
    ds_write_b64 v246, v[46:47] offset:40
    ds_write_b64 v246, v[48:49] offset:48
    ds_write_b64 v246, v[50:51] offset:1824
    ds_write_b64 v246, v[52:53] offset:1832
    ds_write_b64 v246, v[54:55] offset:1840
    ds_write_b64 v246, v[56:57] offset:1848
    ds_write_b64 v246, v[58:59] offset:1856
    ds_write_b64 v246, v[60:61] offset:1864
    ds_write_b64 v246, v[62:63] offset:1872
    s_mul_i32 s50, s42, 7296
    v_add_u32 v247, s50, v244
    s_lshl_b32 s50, s42, 3
    s_add_u32 s50, s50, s49
    s_mul_i32 s52, s50, 128
    s_add_u32 s52, s52, 18350080
    v_lshrrev_b32 v246, 3, v1
    v_lshlrev_b32 v246, 18, v246
    v_and_b32 v244, 0x70, v244
    v_add_u32 v244, v244, v246
    s_waitcnt lgkmcnt(0)
    s_mov_b32 exec_hi, 0x00ffffff
    ds_read_b128 v[178:181], v247 offset:0
    ds_read_b128 v[182:185], v247 offset:912
    ds_read_b128 v[186:189], v247 offset:1824
    ds_read_b128 v[190:193], v247 offset:2736
    ds_read_b128 v[194:197], v247 offset:3648
    ds_read_b128 v[198:201], v247 offset:4560
    ds_read_b128 v[202:205], v247 offset:5472
    ds_read_b128 v[206:209], v247 offset:6384
    s_waitcnt lgkmcnt(7)
    buffer_store_dwordx4 v[178:181], v244, s[16:19], s52 offen sc1
    s_waitcnt lgkmcnt(6)
    s_add_u32 s52, s52, 128
    buffer_store_dwordx4 v[182:185], v244, s[16:19], s52 offen sc1
    s_waitcnt lgkmcnt(5)
    s_add_u32 s52, s52, 128
    buffer_store_dwordx4 v[186:189], v244, s[16:19], s52 offen sc1
    s_waitcnt lgkmcnt(4)
    s_add_u32 s52, s52, 128
    buffer_store_dwordx4 v[190:193], v244, s[16:19], s52 offen sc1
    s_waitcnt lgkmcnt(3)
    s_add_u32 s52, s52, 128
    buffer_store_dwordx4 v[194:197], v244, s[16:19], s52 offen sc1
    s_waitcnt lgkmcnt(2)
    s_add_u32 s52, s52, 128
    buffer_store_dwordx4 v[198:201], v244, s[16:19], s52 offen sc1
    s_waitcnt lgkmcnt(1)
    s_add_u32 s52, s52, 128
    buffer_store_dwordx4 v[202:205], v244, s[16:19], s52 offen sc1
    s_waitcnt lgkmcnt(0)
    s_add_u32 s52, s52, 128
    buffer_store_dwordx4 v[206:209], v244, s[16:19], s52 offen sc1
    s_mov_b32 exec_hi, -1
    s_waitcnt vmcnt(0) lgkmcnt(0)
    s_barrier
    s_cmp_lg_u32 s42, 0
    s_cbranch_scc1 fs_f_25
    s_sub_u32 s62, s2, 224
    s_lshl_b32 s62, s62, 7
    s_add_u32 s62, s62, 22024192
    v_mov_b32 v28, 0
    v_mov_b32 v29, s59
    s_mov_b64 exec, 1
    buffer_store_dword v29, v28, s[16:19], s62 offen sc1
    s_mov_b64 exec, -1
fs_f_25:
    s_sub_u32 s60, s2, 224
    s_lshr_b32 s60, s60, 3
    v_lshlrev_b32 v2, 7, v0
    s_mul_i32 s61, s60, 200704
    buffer_load_dword v30, v2, s[24:27], s61 offen
    s_add_u32 s61, s61, 65536
    buffer_load_dword v31, v2, s[24:27], s61 offen
    s_add_u32 s61, s61, 65536
    buffer_load_dword v32, v2, s[24:27], s61 offen
    s_add_u32 s61, s61, 65536
    v_cmp_gt_u32 vcc, 4096, v2
    s_and_b64 exec, exec, vcc
    buffer_load_dword v33, v2, s[24:27], s61 offen
    s_add_u32 s61, s61, 65536
    s_mov_b64 exec, -1
    s_mul_i32 s61, s60, 100352
    buffer_load_dword v38, v2, s[28:31], s61 offen
    s_add_u32 s61, s61, 65536
    v_cmp_gt_u32 vcc, 34816, v2
    s_and_b64 exec, exec, vcc
    buffer_load_dword v39, v2, s[28:31], s61 offen
    s_add_u32 s61, s61, 65536
    s_mov_b64 exec, -1
    s_waitcnt vmcnt(0)
L_fin_f:
L_end:
    s_endpgm
.section .rodata,"a"
.p2align 6
.amdhsa_kernel f_kernel
  .amdhsa_next_free_vgpr 256
  .amdhsa_next_free_sgpr 102
  .amdhsa_accum_offset 256
  .amdhsa_group_segment_fixed_size 0
  .amdhsa_kernarg_size 88
  .amdhsa_user_sgpr_count 2
  .amdhsa_user_sgpr_kernarg_segment_ptr 1
  .amdhsa_system_sgpr_workgroup_id_x 1
  .amdhsa_float_denorm_mode_32 3
  .amdhsa_float_denorm_mode_16_64 3
.end_amdhsa_kernel
```
